```python
import torch

def _softmax(x, axis=-1):
    return torch.softmax(x, dim=axis)
def _gelu(x):
    return torch.nn.functional.gelu(x, approximate="tanh")
def _silu(x):
    return torch.nn.functional.silu(x)
def _sigmoid(x):
    return torch.sigmoid(x)
def _layernorm(x, axis=-1, eps=1e-5):
    m = x.mean(dim=axis, keepdim=True)
    v = x.var(dim=axis, keepdim=True, unbiased=False)
    return (x - m) / torch.sqrt(v + eps)
def _scatter_add(tgt, idx, src, axis=0):
    return tgt.clone().index_add_(axis, idx, src)
def _segment_sum(src, seg, n):
    out = torch.zeros((n,) + src.shape[1:], dtype=src.dtype)
    return out.index_add_(0, seg, src)
def _pad(x, pw):
    flat = tuple(v for pair in reversed(pw) for v in pair)
    return torch.nn.functional.pad(x, flat)

kernel_name = 'standalone__weight_only_int_gptq__prompt'

def setup_inputs():

    _w = (lambda a: (lambda t: t.to(torch.bfloat16) if t.is_floating_point() else t)(torch.as_tensor(a)))
    B, S, D, F = 1, 2048, 1024, 3584
    bits = max(2, min(4, 3))
    pf = 32 // bits
    G = 64 if 64 > 0 else D
    G = max(pf, (G // pf) * pf)
    D = max(G, (D // G) * G)
    ng = D // G
    qmax = 1 << bits
    qw = torch.randint(0, qmax, (D, F)).to(torch.int64)
    packed = torch.zeros((D // pf, F), dtype=torch.int64)
    for i in range(pf):
        packed |= (qw[i::pf] << (i * bits))
    packed = packed.to(torch.int32)
    return {
        "x": _w((lambda *s: torch.randn(*s, dtype=torch.bfloat16) * 0.05)(B, S, D)),
        "qw_packed": _w(packed),
        "scales": _w(torch.abs((lambda *s: torch.randn(*s, dtype=torch.bfloat16) * 0.05)(ng, F)).to(float) * 0.1 + 0.01),
        "zeros": _w(torch.randint(0, qmax, (ng, F)).to(float)),
        "bits": _w((lambda _x: torch.as_tensor(_x, dtype=torch.int32))(bits)),
    }

def reference(x, qw_packed, scales, zeros, bits):
    b = int(bits)
    pf = 32 // b
    mask = (1 << b) - 1
    P, F = qw_packed.shape
    D = P * pf
    ng = scales.shape[0]
    G = D // ng
    shifts = (lambda x, dt: x.to(dt))(torch.arange(pf) * b, qw_packed.dtype)
    qw = ((qw_packed[:, None, :] >> shifts[None, :, None]) & mask).reshape(D, F)
    s = (lambda x, n, axis: torch.repeat_interleave(x, n, dim=axis))(scales, G, axis=0)
    z = (lambda x, n, axis: torch.repeat_interleave(x, n, dim=axis))(zeros, G, axis=0)
    w = ((lambda x, dt: x.to(dt))(qw, x.dtype) - z) * s
    return torch.einsum("bsd,df->bsf", x, w)
```

```asm
; @launch grid=(256,1,1) block=(512,1,1) lds=163840
.amdgcn_target "amdgcn-amd-amdhsa--gfx950"
.text
.globl standalone__weight_only_int_gptq__prompt_kernel
.p2align 12
.fill 64, 4, 0xbf810000
.p2align 8
.type standalone__weight_only_int_gptq__prompt_kernel,@function
standalone__weight_only_int_gptq__prompt_kernel:
    s_load_dwordx2 s[12:13], s[0:1], 8
    s_load_dwordx2 s[16:17], s[0:1], 16
    s_load_dwordx2 s[20:21], s[0:1], 24
    s_load_dwordx2 s[8:9], s[0:1], 0
    s_load_dwordx2 s[24:25], s[0:1], 40
    s_bfe_u32 s4, s2, 0x20001
    s_lshl_b32 s4, s4, 5
    s_lshr_b32 s46, s2, 3
    s_add_u32 s53, s4, s46
    s_cmp_ge_u32 s2, 256
    s_cbranch_scc1 L_end
    s_cmp_ge_u32 s53, 126
    s_cbranch_scc1 L_end
    v_lshrrev_b32 v8, 6, v0
    v_and_b32 v4, 63, v0
    v_readfirstlane_b32 s36, v8
    s_getpc_b64 s[4:5]
    s_lshr_b32 s3, s2, 3
    s_lshl_b32 s3, s3, 5
    v_and_b32 v2, 3, v0
    v_lshl_add_u32 v1, v8, 2, v2
    v_add_u32 v1, s3, v1
    v_and_b32 v1, 255, v1
    v_lshlrev_b32 v1, 7, v1
    v_min_u32 v1, CODE_BYTES, v1
    global_load_dword v3, v1, s[4:5]
    s_mul_i32 s38, s53, 4682
    s_lshr_b32 s38, s38, 16
    s_mul_i32 s39, s38, 14
    s_sub_u32 s39, s53, s39
    s_and_b32 s37, s2, 1
    s_mul_i32 s37, s37, 14
    s_add_u32 s37, s37, s39
    s_and_b32 s40, s36, 3
    s_lshl_b32 s50, s37, 7
    s_lshl_b32 s46, s40, 5
    s_add_u32 s50, s50, s46
    s_mul_i32 s49, s40, 7680
    s_add_u32 s49, s49, 133120
    s_mov_b32 s14, 1462272
    s_mov_b32 s15, 0x20000
    s_mov_b32 s18, 121856
    s_mov_b32 s19, 0x20000
    s_mov_b32 s22, 121856
    s_mov_b32 s23, 0x20000
    s_mov_b32 s10, 4177920
    s_mov_b32 s11, 0x20000
    v_lshrrev_b32 v6, 5, v4
    v_lshrrev_b32 v10, 4, v4
    v_and_b32 v45, 7, v4
    s_lshl_b32 s46, s50, 2
    v_lshl_add_u32 v45, v45, 4, s46
    v_bfe_u32 v11, v4, 3, 2
    v_mad_u32_u24 v9, v11, 12, v6
    v_mul_u32_u24 v44, 14336, v9
    v_add_u32 v44, v44, v45
    v_and_b32 v7, 3, v4
    v_bfe_u32 v9, v4, 2, 2
    v_lshl_or_b32 v7, v7, 2, v9
    s_lshl_b32 s46, s50, 1
    v_lshl_add_u32 v48, v7, 2, s46
    v_mul_u32_u24 v46, 14336, v10
    v_add_u32 v46, v46, v48
    s_cmp_ge_u32 s36, 4
    s_cbranch_scc1 L_Y
    s_setprio 2
    s_waitcnt lgkmcnt(0)
    s_add_u32 m0, s49, 0
    s_mov_b32 s47, 0
    buffer_load_dwordx4 v44, s[12:15], s47 offen lds
    s_mov_b32 s48, 0
    buffer_load_dword v56, v46, s[16:19], s48 offen
    buffer_load_dword v57, v46, s[20:23], s48 offen
    s_add_u32 m0, s49, 1024
    s_mov_b32 s47, 28672
    buffer_load_dwordx4 v44, s[12:15], s47 offen lds
    s_add_u32 m0, s49, 2048
    s_mov_b32 s47, 57344
    buffer_load_dwordx4 v44, s[12:15], s47 offen lds
    v_max_u32 v12, 1, v11
    v_add_u32 v12, -1, v12
    v_add_u32 v12, v12, v6
    v_mul_u32_u24 v12, 14336, v12
    v_add_u32 v45, v45, v12
    v_lshlrev_b32 v47, 3, v7
    v_lshl_add_u32 v47, v10, 7, v47
    v_add_u32 v47, s49, v47
    v_mov_b32 v156, 0x0007000e
    v_mov_b32 v157, 0x00380070
    v_mov_b32 v158, 0x01c00380
    s_mov_b32 s34, 0x48000000
    s_mov_b32 s35, 0x3fffffff
    s_mov_b32 s52, 0xffff0000
    v_lshlrev_b32 v12, 3, v10
    s_mov_b32 s45, 0x0c121800
    s_add_u32 m0, s49, 3072
    s_mov_b32 s47, 86016
    buffer_load_dwordx4 v44, s[12:15], s47 offen lds
    v_lshrrev_b32 v161, v12, s45
    v_and_b32 v161, 0xff, v161
    v_sub_u32 v162, 30, v161
    v_and_b32 v12, 15, v4
    v_mul_u32_u24 v168, 1040, v12
    v_lshl_add_u32 v168, v10, 8, v168
    v_add_u32 v169, 66560, v168
    s_lshl_b32 s45, s40, 12
    s_mov_b32 s48, 7168
    buffer_load_dword v58, v46, s[16:19], s48 offen
    buffer_load_dword v59, v46, s[20:23], s48 offen
    s_add_u32 s45, s45, 99840
    v_lshl_add_u32 v172, v4, 4, s45
    v_add_u32 v173, 133120, v168
    v_and_b32 v12, 15, v4
    v_mul_u32_u24 v170, 240, v10
    v_lshl_add_u32 v170, v12, 4, v170
    v_cmp_eq_u32 vcc, 15, v12
    v_lshlrev_b32 v13, 4, v10
    s_add_u32 m0, s49, 4096
    s_mov_b32 s47, 114688
    buffer_load_dwordx4 v44, s[12:15], s47 offen lds
    v_add_u32 v171, 960, v170
    v_add_u32 v14, 1920, v13
    v_add_u32 v13, 1984, v13
    v_min_u32 v13, 2024, v13
    v_cndmask_b32 v170, v170, v14, vcc
    v_cndmask_b32 v171, v171, v13, vcc
    s_cmp_eq_u32 s38, 7
    s_cselect_b32 s41, 1, 0
    s_cmp_eq_u32 s38, 8
    s_cselect_b32 s41, 1, s41
    s_add_u32 m0, s49, 5120
    s_mov_b32 s47, 143360
    buffer_load_dwordx4 v44, s[12:15], s47 offen lds
    s_mul_i32 s45, s38, 14
    s_cmp_gt_u32 s38, 7
    s_addc_u32 s45, s45, 0
    s_cmp_gt_u32 s38, 8
    s_addc_u32 s38, s45, 0
    s_mov_b32 s69, s39
    s_mov_b32 s70, 0x4152630
    s_mov_b32 s71, 0x415263
    s_lshl_b32 s39, s39, 2
    s_lshr_b64 s[70:71], s[70:71], s39
    s_add_u32 m0, s49, 6144
    s_mov_b32 s47, 1376256
    buffer_load_dwordx4 v45, s[12:15], s47 offen lds
    s_and_b32 s39, s70, 15
    s_mul_i32 s43, s38, 32640
    s_mul_i32 s45, s40, 16320
    s_add_u32 s43, s43, s45
    s_mul_i32 s42, s40, 8320
    s_mov_b32 s48, 114688
    buffer_load_dword v163, v48, s[16:19], s48 offen
    buffer_load_dword v164, v48, s[20:23], s48 offen
    s_waitcnt vmcnt(12)
    ds_read_b64 v[100:101], v47 offset:0
    s_waitcnt vmcnt(11)
    s_waitcnt vmcnt(10)
    v_lshlrev_b32 v159, 16, v56
    v_lshlrev_b32 v160, 16, v57
    v_mul_f32 v144, s34, v159
    v_mul_f32 v148, v160, v159
    v_mul_f32 v147, 2.0, v144
    v_mul_f32 v143, 4.0, v147
    v_mul_f32 v146, 2.0, v143
    v_mul_f32 v142, 4.0, v146
    v_mul_f32 v145, 2.0, v142
    s_waitcnt lgkmcnt(0)
    v_add_u32 v135, v100, v100
    v_lshrrev_b32 v137, 8, v100
    v_and_b32 v133, v156, v135
    v_and_b32 v134, v157, v135
    v_and_b32 v135, v158, v135
    v_and_b32 v136, v156, v137
    v_and_b32 v137, v157, v137
    v_fma_mix_f32 v138, v133, v142, -v148 op_sel:[0,0,0] op_sel_hi:[1,0,0]
    v_fma_mix_f32 v139, v134, v143, -v148 op_sel:[0,0,0] op_sel_hi:[1,0,0]
    v_add_u32 v130, v101, v101
    v_fma_mix_f32 v140, v135, v144, -v148 op_sel:[0,0,0] op_sel_hi:[1,0,0]
    v_fma_mix_f32 v141, v136, v142, -v148 op_sel:[0,0,0] op_sel_hi:[1,0,0]
    v_lshrrev_b32 v132, 8, v101
    v_cvt_pk_bf16_f32 v0, v138, v139
    v_fma_mix_f32 v138, v137, v143, -v148 op_sel:[0,0,0] op_sel_hi:[1,0,0]
    v_and_b32 v128, v156, v130
    ds_read_b64 v[102:103], v47 offset:512
    v_fma_mix_f32 v139, v133, v145, -v148 op_sel:[1,0,0] op_sel_hi:[1,0,0]
    v_cvt_pk_bf16_f32 v1, v140, v141
    v_and_b32 v129, v157, v130
    v_fma_mix_f32 v140, v134, v146, -v148 op_sel:[1,0,0] op_sel_hi:[1,0,0]
    v_fma_mix_f32 v141, v135, v147, -v148 op_sel:[1,0,0] op_sel_hi:[1,0,0]
    v_and_b32 v130, v158, v130
    v_cvt_pk_bf16_f32 v2, v138, v139
    v_fma_mix_f32 v138, v136, v145, -v148 op_sel:[1,0,0] op_sel_hi:[1,0,0]
    v_and_b32 v131, v156, v132
    v_fma_mix_f32 v139, v137, v146, -v148 op_sel:[1,0,0] op_sel_hi:[1,0,0]
    v_cvt_pk_bf16_f32 v3, v140, v141
    v_and_b32 v132, v157, v132
    v_cvt_pk_bf16_f32 v4, v138, v139
    v_and_b32 v159, s52, v56
    v_and_b32 v160, s52, v57
    v_mul_f32 v151, s34, v159
    v_mul_f32 v155, v160, v159
    v_mul_f32 v154, 2.0, v151
    v_mul_f32 v150, 4.0, v154
    v_mul_f32 v153, 2.0, v150
    v_mul_f32 v149, 4.0, v153
    v_mul_f32 v152, 2.0, v149
    v_fma_mix_f32 v138, v128, v149, -v155 op_sel:[0,0,0] op_sel_hi:[1,0,0]
    v_fma_mix_f32 v139, v129, v150, -v155 op_sel:[0,0,0] op_sel_hi:[1,0,0]
    s_waitcnt lgkmcnt(0)
    v_add_u32 v135, v102, v102
    v_fma_mix_f32 v140, v130, v151, -v155 op_sel:[0,0,0] op_sel_hi:[1,0,0]
    v_fma_mix_f32 v141, v131, v149, -v155 op_sel:[0,0,0] op_sel_hi:[1,0,0]
    v_lshrrev_b32 v137, 8, v102
    v_cvt_pk_bf16_f32 v64, v138, v139
    v_fma_mix_f32 v138, v132, v150, -v155 op_sel:[0,0,0] op_sel_hi:[1,0,0]
    v_and_b32 v133, v156, v135
    v_fma_mix_f32 v139, v128, v152, -v155 op_sel:[1,0,0] op_sel_hi:[1,0,0]
    v_cvt_pk_bf16_f32 v65, v140, v141
    v_and_b32 v134, v157, v135
    v_fma_mix_f32 v140, v129, v153, -v155 op_sel:[1,0,0] op_sel_hi:[1,0,0]
    v_fma_mix_f32 v141, v130, v154, -v155 op_sel:[1,0,0] op_sel_hi:[1,0,0]
    v_and_b32 v135, v158, v135
    v_cvt_pk_bf16_f32 v66, v138, v139
    v_fma_mix_f32 v138, v131, v152, -v155 op_sel:[1,0,0] op_sel_hi:[1,0,0]
    v_and_b32 v136, v156, v137
    v_fma_mix_f32 v139, v132, v153, -v155 op_sel:[1,0,0] op_sel_hi:[1,0,0]
    v_cvt_pk_bf16_f32 v67, v140, v141
    v_and_b32 v137, v157, v137
    v_cvt_pk_bf16_f32 v68, v138, v139
    s_waitcnt vmcnt(9)
    ds_read_b64 v[104:105], v47 offset:1024
    v_fma_mix_f32 v138, v133, v142, -v148 op_sel:[0,0,0] op_sel_hi:[1,0,0]
    v_fma_mix_f32 v139, v134, v143, -v148 op_sel:[0,0,0] op_sel_hi:[1,0,0]
    v_add_u32 v130, v103, v103
    v_fma_mix_f32 v140, v135, v144, -v148 op_sel:[0,0,0] op_sel_hi:[1,0,0]
    v_fma_mix_f32 v141, v136, v142, -v148 op_sel:[0,0,0] op_sel_hi:[1,0,0]
    v_lshrrev_b32 v132, 8, v103
    v_cvt_pk_bf16_f32 v5, v138, v139
    v_fma_mix_f32 v138, v137, v143, -v148 op_sel:[0,0,0] op_sel_hi:[1,0,0]
    v_and_b32 v128, v156, v130
    v_fma_mix_f32 v139, v133, v145, -v148 op_sel:[1,0,0] op_sel_hi:[1,0,0]
    v_cvt_pk_bf16_f32 v6, v140, v141
    v_and_b32 v129, v157, v130
    v_fma_mix_f32 v140, v134, v146, -v148 op_sel:[1,0,0] op_sel_hi:[1,0,0]
    v_fma_mix_f32 v141, v135, v147, -v148 op_sel:[1,0,0] op_sel_hi:[1,0,0]
    v_and_b32 v130, v158, v130
    v_cvt_pk_bf16_f32 v7, v138, v139
    v_fma_mix_f32 v138, v136, v145, -v148 op_sel:[1,0,0] op_sel_hi:[1,0,0]
    v_and_b32 v131, v156, v132
    v_fma_mix_f32 v139, v137, v146, -v148 op_sel:[1,0,0] op_sel_hi:[1,0,0]
    v_cvt_pk_bf16_f32 v8, v140, v141
    v_and_b32 v132, v157, v132
    v_cvt_pk_bf16_f32 v9, v138, v139
    v_fma_mix_f32 v138, v128, v149, -v155 op_sel:[0,0,0] op_sel_hi:[1,0,0]
    v_fma_mix_f32 v139, v129, v150, -v155 op_sel:[0,0,0] op_sel_hi:[1,0,0]
    s_waitcnt lgkmcnt(0)
    v_add_u32 v135, v104, v104
    v_fma_mix_f32 v140, v130, v151, -v155 op_sel:[0,0,0] op_sel_hi:[1,0,0]
    v_fma_mix_f32 v141, v131, v149, -v155 op_sel:[0,0,0] op_sel_hi:[1,0,0]
    v_lshrrev_b32 v137, 8, v104
    v_cvt_pk_bf16_f32 v69, v138, v139
    v_fma_mix_f32 v138, v132, v150, -v155 op_sel:[0,0,0] op_sel_hi:[1,0,0]
    v_and_b32 v133, v156, v135
    v_fma_mix_f32 v139, v128, v152, -v155 op_sel:[1,0,0] op_sel_hi:[1,0,0]
    v_cvt_pk_bf16_f32 v70, v140, v141
    v_and_b32 v134, v157, v135
    v_fma_mix_f32 v140, v129, v153, -v155 op_sel:[1,0,0] op_sel_hi:[1,0,0]
    v_fma_mix_f32 v141, v130, v154, -v155 op_sel:[1,0,0] op_sel_hi:[1,0,0]
    v_and_b32 v135, v158, v135
    v_cvt_pk_bf16_f32 v71, v138, v139
    v_fma_mix_f32 v138, v131, v152, -v155 op_sel:[1,0,0] op_sel_hi:[1,0,0]
    v_and_b32 v136, v156, v137
    v_fma_mix_f32 v139, v132, v153, -v155 op_sel:[1,0,0] op_sel_hi:[1,0,0]
    v_cvt_pk_bf16_f32 v72, v140, v141
    v_and_b32 v137, v157, v137
    v_cvt_pk_bf16_f32 v73, v138, v139
    ds_read_b64 v[106:107], v47 offset:1536
    v_fma_mix_f32 v138, v133, v142, -v148 op_sel:[0,0,0] op_sel_hi:[1,0,0]
    v_fma_mix_f32 v139, v134, v143, -v148 op_sel:[0,0,0] op_sel_hi:[1,0,0]
    v_add_u32 v130, v105, v105
    v_fma_mix_f32 v140, v135, v144, -v148 op_sel:[0,0,0] op_sel_hi:[1,0,0]
    v_fma_mix_f32 v141, v136, v142, -v148 op_sel:[0,0,0] op_sel_hi:[1,0,0]
    v_lshrrev_b32 v132, 8, v105
    v_cvt_pk_bf16_f32 v10, v138, v139
    v_fma_mix_f32 v138, v137, v143, -v148 op_sel:[0,0,0] op_sel_hi:[1,0,0]
    v_and_b32 v128, v156, v130
    v_fma_mix_f32 v139, v133, v145, -v148 op_sel:[1,0,0] op_sel_hi:[1,0,0]
    v_cvt_pk_bf16_f32 v11, v140, v141
    v_and_b32 v129, v157, v130
    v_fma_mix_f32 v140, v134, v146, -v148 op_sel:[1,0,0] op_sel_hi:[1,0,0]
    v_fma_mix_f32 v141, v135, v147, -v148 op_sel:[1,0,0] op_sel_hi:[1,0,0]
    v_and_b32 v130, v158, v130
    v_cvt_pk_bf16_f32 v12, v138, v139
    v_fma_mix_f32 v138, v136, v145, -v148 op_sel:[1,0,0] op_sel_hi:[1,0,0]
    v_and_b32 v131, v156, v132
    v_fma_mix_f32 v139, v137, v146, -v148 op_sel:[1,0,0] op_sel_hi:[1,0,0]
    v_cvt_pk_bf16_f32 v13, v140, v141
    v_and_b32 v132, v157, v132
    v_cvt_pk_bf16_f32 v14, v138, v139
    v_fma_mix_f32 v138, v128, v149, -v155 op_sel:[0,0,0] op_sel_hi:[1,0,0]
    v_fma_mix_f32 v139, v129, v150, -v155 op_sel:[0,0,0] op_sel_hi:[1,0,0]
    s_waitcnt lgkmcnt(0)
    v_add_u32 v135, v106, v106
    v_fma_mix_f32 v140, v130, v151, -v155 op_sel:[0,0,0] op_sel_hi:[1,0,0]
    v_fma_mix_f32 v141, v131, v149, -v155 op_sel:[0,0,0] op_sel_hi:[1,0,0]
    v_lshrrev_b32 v137, 8, v106
    v_cvt_pk_bf16_f32 v74, v138, v139
    v_fma_mix_f32 v138, v132, v150, -v155 op_sel:[0,0,0] op_sel_hi:[1,0,0]
    v_and_b32 v133, v156, v135
    v_fma_mix_f32 v139, v128, v152, -v155 op_sel:[1,0,0] op_sel_hi:[1,0,0]
    v_cvt_pk_bf16_f32 v75, v140, v141
    v_and_b32 v134, v157, v135
    v_fma_mix_f32 v140, v129, v153, -v155 op_sel:[1,0,0] op_sel_hi:[1,0,0]
    v_fma_mix_f32 v141, v130, v154, -v155 op_sel:[1,0,0] op_sel_hi:[1,0,0]
    v_and_b32 v135, v158, v135
    v_cvt_pk_bf16_f32 v76, v138, v139
    v_fma_mix_f32 v138, v131, v152, -v155 op_sel:[1,0,0] op_sel_hi:[1,0,0]
    v_and_b32 v136, v156, v137
    v_fma_mix_f32 v139, v132, v153, -v155 op_sel:[1,0,0] op_sel_hi:[1,0,0]
    v_cvt_pk_bf16_f32 v77, v140, v141
    v_and_b32 v137, v157, v137
    v_cvt_pk_bf16_f32 v78, v138, v139
    s_waitcnt vmcnt(8)
    ds_read_b64 v[108:109], v47 offset:2048
    v_fma_mix_f32 v138, v133, v142, -v148 op_sel:[0,0,0] op_sel_hi:[1,0,0]
    v_fma_mix_f32 v139, v134, v143, -v148 op_sel:[0,0,0] op_sel_hi:[1,0,0]
    v_add_u32 v130, v107, v107
    v_fma_mix_f32 v140, v135, v144, -v148 op_sel:[0,0,0] op_sel_hi:[1,0,0]
    v_fma_mix_f32 v141, v136, v142, -v148 op_sel:[0,0,0] op_sel_hi:[1,0,0]
    v_lshrrev_b32 v132, 8, v107
    v_cvt_pk_bf16_f32 v15, v138, v139
    v_fma_mix_f32 v138, v137, v143, -v148 op_sel:[0,0,0] op_sel_hi:[1,0,0]
    v_and_b32 v128, v156, v130
    v_fma_mix_f32 v139, v133, v145, -v148 op_sel:[1,0,0] op_sel_hi:[1,0,0]
    v_cvt_pk_bf16_f32 v16, v140, v141
    v_and_b32 v129, v157, v130
    v_fma_mix_f32 v140, v134, v146, -v148 op_sel:[1,0,0] op_sel_hi:[1,0,0]
    v_fma_mix_f32 v141, v135, v147, -v148 op_sel:[1,0,0] op_sel_hi:[1,0,0]
    v_and_b32 v130, v158, v130
    v_cvt_pk_bf16_f32 v17, v138, v139
    v_fma_mix_f32 v138, v136, v145, -v148 op_sel:[1,0,0] op_sel_hi:[1,0,0]
    v_and_b32 v131, v156, v132
    v_fma_mix_f32 v139, v137, v146, -v148 op_sel:[1,0,0] op_sel_hi:[1,0,0]
    v_cvt_pk_bf16_f32 v18, v140, v141
    v_and_b32 v132, v157, v132
    v_cvt_pk_bf16_f32 v19, v138, v139
    v_fma_mix_f32 v138, v128, v149, -v155 op_sel:[0,0,0] op_sel_hi:[1,0,0]
    v_fma_mix_f32 v139, v129, v150, -v155 op_sel:[0,0,0] op_sel_hi:[1,0,0]
    s_waitcnt lgkmcnt(0)
    v_add_u32 v135, v108, v108
    v_fma_mix_f32 v140, v130, v151, -v155 op_sel:[0,0,0] op_sel_hi:[1,0,0]
    v_fma_mix_f32 v141, v131, v149, -v155 op_sel:[0,0,0] op_sel_hi:[1,0,0]
    v_lshrrev_b32 v137, 8, v108
    v_cvt_pk_bf16_f32 v79, v138, v139
    v_fma_mix_f32 v138, v132, v150, -v155 op_sel:[0,0,0] op_sel_hi:[1,0,0]
    v_and_b32 v133, v156, v135
    v_fma_mix_f32 v139, v128, v152, -v155 op_sel:[1,0,0] op_sel_hi:[1,0,0]
    v_cvt_pk_bf16_f32 v80, v140, v141
    v_and_b32 v134, v157, v135
    v_fma_mix_f32 v140, v129, v153, -v155 op_sel:[1,0,0] op_sel_hi:[1,0,0]
    v_fma_mix_f32 v141, v130, v154, -v155 op_sel:[1,0,0] op_sel_hi:[1,0,0]
    v_and_b32 v135, v158, v135
    v_cvt_pk_bf16_f32 v81, v138, v139
    v_fma_mix_f32 v138, v131, v152, -v155 op_sel:[1,0,0] op_sel_hi:[1,0,0]
    v_and_b32 v136, v156, v137
    v_fma_mix_f32 v139, v132, v153, -v155 op_sel:[1,0,0] op_sel_hi:[1,0,0]
    v_cvt_pk_bf16_f32 v82, v140, v141
    v_and_b32 v137, v157, v137
    v_cvt_pk_bf16_f32 v83, v138, v139
    ds_read_b64 v[110:111], v47 offset:2560
    v_fma_mix_f32 v138, v133, v142, -v148 op_sel:[0,0,0] op_sel_hi:[1,0,0]
    v_fma_mix_f32 v139, v134, v143, -v148 op_sel:[0,0,0] op_sel_hi:[1,0,0]
    v_add_u32 v130, v109, v109
    v_fma_mix_f32 v140, v135, v144, -v148 op_sel:[0,0,0] op_sel_hi:[1,0,0]
    v_fma_mix_f32 v141, v136, v142, -v148 op_sel:[0,0,0] op_sel_hi:[1,0,0]
    v_lshrrev_b32 v132, 8, v109
    v_cvt_pk_bf16_f32 v20, v138, v139
    v_fma_mix_f32 v138, v137, v143, -v148 op_sel:[0,0,0] op_sel_hi:[1,0,0]
    v_and_b32 v128, v156, v130
    v_fma_mix_f32 v139, v133, v145, -v148 op_sel:[1,0,0] op_sel_hi:[1,0,0]
    v_cvt_pk_bf16_f32 v21, v140, v141
    v_and_b32 v129, v157, v130
    v_fma_mix_f32 v140, v134, v146, -v148 op_sel:[1,0,0] op_sel_hi:[1,0,0]
    v_fma_mix_f32 v141, v135, v147, -v148 op_sel:[1,0,0] op_sel_hi:[1,0,0]
    v_and_b32 v130, v158, v130
    v_cvt_pk_bf16_f32 v22, v138, v139
    v_fma_mix_f32 v138, v136, v145, -v148 op_sel:[1,0,0] op_sel_hi:[1,0,0]
    v_and_b32 v131, v156, v132
    v_fma_mix_f32 v139, v137, v146, -v148 op_sel:[1,0,0] op_sel_hi:[1,0,0]
    v_cvt_pk_bf16_f32 v23, v140, v141
    v_and_b32 v132, v157, v132
    v_cvt_pk_bf16_f32 v24, v138, v139
    v_fma_mix_f32 v138, v128, v149, -v155 op_sel:[0,0,0] op_sel_hi:[1,0,0]
    v_fma_mix_f32 v139, v129, v150, -v155 op_sel:[0,0,0] op_sel_hi:[1,0,0]
    s_waitcnt lgkmcnt(0)
    v_add_u32 v135, v110, v110
    v_fma_mix_f32 v140, v130, v151, -v155 op_sel:[0,0,0] op_sel_hi:[1,0,0]
    v_fma_mix_f32 v141, v131, v149, -v155 op_sel:[0,0,0] op_sel_hi:[1,0,0]
    v_lshrrev_b32 v137, 8, v110
    v_cvt_pk_bf16_f32 v84, v138, v139
    v_fma_mix_f32 v138, v132, v150, -v155 op_sel:[0,0,0] op_sel_hi:[1,0,0]
    v_and_b32 v133, v156, v135
    v_fma_mix_f32 v139, v128, v152, -v155 op_sel:[1,0,0] op_sel_hi:[1,0,0]
    v_cvt_pk_bf16_f32 v85, v140, v141
    v_and_b32 v134, v157, v135
    v_fma_mix_f32 v140, v129, v153, -v155 op_sel:[1,0,0] op_sel_hi:[1,0,0]
    v_fma_mix_f32 v141, v130, v154, -v155 op_sel:[1,0,0] op_sel_hi:[1,0,0]
    v_and_b32 v135, v158, v135
    v_cvt_pk_bf16_f32 v86, v138, v139
    v_fma_mix_f32 v138, v131, v152, -v155 op_sel:[1,0,0] op_sel_hi:[1,0,0]
    v_and_b32 v136, v156, v137
    v_fma_mix_f32 v139, v132, v153, -v155 op_sel:[1,0,0] op_sel_hi:[1,0,0]
    v_cvt_pk_bf16_f32 v87, v140, v141
    v_and_b32 v137, v157, v137
    v_cvt_pk_bf16_f32 v88, v138, v139
    s_waitcnt vmcnt(7)
    ds_read_b64 v[112:113], v47 offset:3072
    v_fma_mix_f32 v138, v133, v142, -v148 op_sel:[0,0,0] op_sel_hi:[1,0,0]
    v_fma_mix_f32 v139, v134, v143, -v148 op_sel:[0,0,0] op_sel_hi:[1,0,0]
    v_add_u32 v130, v111, v111
    v_fma_mix_f32 v140, v135, v144, -v148 op_sel:[0,0,0] op_sel_hi:[1,0,0]
    v_fma_mix_f32 v141, v136, v142, -v148 op_sel:[0,0,0] op_sel_hi:[1,0,0]
    v_lshrrev_b32 v132, 8, v111
    v_cvt_pk_bf16_f32 v25, v138, v139
    v_fma_mix_f32 v138, v137, v143, -v148 op_sel:[0,0,0] op_sel_hi:[1,0,0]
    v_and_b32 v128, v156, v130
    v_fma_mix_f32 v139, v133, v145, -v148 op_sel:[1,0,0] op_sel_hi:[1,0,0]
    v_cvt_pk_bf16_f32 v26, v140, v141
    v_and_b32 v129, v157, v130
    v_fma_mix_f32 v140, v134, v146, -v148 op_sel:[1,0,0] op_sel_hi:[1,0,0]
    v_fma_mix_f32 v141, v135, v147, -v148 op_sel:[1,0,0] op_sel_hi:[1,0,0]
    v_and_b32 v130, v158, v130
    v_cvt_pk_bf16_f32 v27, v138, v139
    v_fma_mix_f32 v138, v136, v145, -v148 op_sel:[1,0,0] op_sel_hi:[1,0,0]
    v_and_b32 v131, v156, v132
    v_fma_mix_f32 v139, v137, v146, -v148 op_sel:[1,0,0] op_sel_hi:[1,0,0]
    v_cvt_pk_bf16_f32 v28, v140, v141
    v_and_b32 v132, v157, v132
    v_cvt_pk_bf16_f32 v29, v138, v139
    v_fma_mix_f32 v138, v128, v149, -v155 op_sel:[0,0,0] op_sel_hi:[1,0,0]
    v_fma_mix_f32 v139, v129, v150, -v155 op_sel:[0,0,0] op_sel_hi:[1,0,0]
    s_waitcnt lgkmcnt(0)
    v_add_u32 v135, v112, v112
    v_fma_mix_f32 v140, v130, v151, -v155 op_sel:[0,0,0] op_sel_hi:[1,0,0]
    v_fma_mix_f32 v141, v131, v149, -v155 op_sel:[0,0,0] op_sel_hi:[1,0,0]
    v_lshrrev_b32 v137, 8, v112
    v_cvt_pk_bf16_f32 v89, v138, v139
    v_fma_mix_f32 v138, v132, v150, -v155 op_sel:[0,0,0] op_sel_hi:[1,0,0]
    v_and_b32 v133, v156, v135
    v_fma_mix_f32 v139, v128, v152, -v155 op_sel:[1,0,0] op_sel_hi:[1,0,0]
    v_cvt_pk_bf16_f32 v90, v140, v141
    v_and_b32 v134, v157, v135
    v_fma_mix_f32 v140, v129, v153, -v155 op_sel:[1,0,0] op_sel_hi:[1,0,0]
    v_fma_mix_f32 v141, v130, v154, -v155 op_sel:[1,0,0] op_sel_hi:[1,0,0]
    v_and_b32 v135, v158, v135
    v_cvt_pk_bf16_f32 v91, v138, v139
    v_fma_mix_f32 v138, v131, v152, -v155 op_sel:[1,0,0] op_sel_hi:[1,0,0]
    v_and_b32 v136, v156, v137
    ds_read_b64 v[114:115], v47 offset:3584
    v_fma_mix_f32 v139, v132, v153, -v155 op_sel:[1,0,0] op_sel_hi:[1,0,0]
    v_cvt_pk_bf16_f32 v92, v140, v141
    v_and_b32 v137, v157, v137
    v_cvt_pk_bf16_f32 v93, v138, v139
    s_waitcnt vmcnt(6)
    s_waitcnt vmcnt(5)
    v_lshlrev_b32 v159, 16, v58
    s_waitcnt vmcnt(4)
    ds_read_b64 v[116:117], v47 offset:4096
    v_lshlrev_b32 v160, 16, v59
    v_mul_f32 v144, s34, v159
    v_mul_f32 v148, v160, v159
    v_mul_f32 v147, 2.0, v144
    v_mul_f32 v143, 4.0, v147
    ds_read_b64 v[118:119], v47 offset:4608
    v_mul_f32 v146, 2.0, v143
    v_mul_f32 v142, 4.0, v146
    v_mul_f32 v145, 2.0, v142
    v_fma_mix_f32 v138, v133, v142, -v148 op_sel:[0,0,0] op_sel_hi:[1,0,0]
    v_fma_mix_f32 v139, v134, v143, -v148 op_sel:[0,0,0] op_sel_hi:[1,0,0]
    s_waitcnt vmcnt(3)
    ds_read_b64 v[120:121], v47 offset:5120
    v_add_u32 v130, v113, v113
    v_fma_mix_f32 v140, v135, v144, -v148 op_sel:[0,0,0] op_sel_hi:[1,0,0]
    v_fma_mix_f32 v141, v136, v142, -v148 op_sel:[0,0,0] op_sel_hi:[1,0,0]
    v_lshrrev_b32 v132, 8, v113
    v_cvt_pk_bf16_f32 v30, v138, v139
    ds_read_b64 v[122:123], v47 offset:5632
    v_fma_mix_f32 v138, v137, v143, -v148 op_sel:[0,0,0] op_sel_hi:[1,0,0]
    v_and_b32 v128, v156, v130
    v_fma_mix_f32 v139, v133, v145, -v148 op_sel:[1,0,0] op_sel_hi:[1,0,0]
    v_cvt_pk_bf16_f32 v31, v140, v141
    v_and_b32 v129, v157, v130
    s_waitcnt vmcnt(2)
    ds_read_b64 v[124:125], v47 offset:6144
    v_fma_mix_f32 v140, v134, v146, -v148 op_sel:[1,0,0] op_sel_hi:[1,0,0]
    v_fma_mix_f32 v141, v135, v147, -v148 op_sel:[1,0,0] op_sel_hi:[1,0,0]
    v_and_b32 v130, v158, v130
    v_cvt_pk_bf16_f32 v32, v138, v139
    v_fma_mix_f32 v138, v136, v145, -v148 op_sel:[1,0,0] op_sel_hi:[1,0,0]
    ds_read_b64 v[126:127], v47 offset:6656
    v_and_b32 v131, v156, v132
    v_fma_mix_f32 v139, v137, v146, -v148 op_sel:[1,0,0] op_sel_hi:[1,0,0]
    v_cvt_pk_bf16_f32 v33, v140, v141
    v_and_b32 v132, v157, v132
    v_cvt_pk_bf16_f32 v34, v138, v139
    v_and_b32 v159, s52, v58
    v_and_b32 v160, s52, v59
    v_mul_f32 v151, s34, v159
    v_mul_f32 v155, v160, v159
    v_mul_f32 v154, 2.0, v151
    v_mul_f32 v150, 4.0, v154
    v_mul_f32 v153, 2.0, v150
    v_mul_f32 v149, 4.0, v153
    v_mul_f32 v152, 2.0, v149
    v_fma_mix_f32 v138, v128, v149, -v155 op_sel:[0,0,0] op_sel_hi:[1,0,0]
    v_fma_mix_f32 v139, v129, v150, -v155 op_sel:[0,0,0] op_sel_hi:[1,0,0]
    s_waitcnt lgkmcnt(6)
    v_add_u32 v135, v114, v114
    v_fma_mix_f32 v140, v130, v151, -v155 op_sel:[0,0,0] op_sel_hi:[1,0,0]
    v_fma_mix_f32 v141, v131, v149, -v155 op_sel:[0,0,0] op_sel_hi:[1,0,0]
    v_lshrrev_b32 v137, 8, v114
    v_cvt_pk_bf16_f32 v94, v138, v139
    v_fma_mix_f32 v138, v132, v150, -v155 op_sel:[0,0,0] op_sel_hi:[1,0,0]
    v_and_b32 v133, v156, v135
    v_fma_mix_f32 v139, v128, v152, -v155 op_sel:[1,0,0] op_sel_hi:[1,0,0]
    v_cvt_pk_bf16_f32 v95, v140, v141
    v_and_b32 v134, v157, v135
    v_fma_mix_f32 v140, v129, v153, -v155 op_sel:[1,0,0] op_sel_hi:[1,0,0]
    v_fma_mix_f32 v141, v130, v154, -v155 op_sel:[1,0,0] op_sel_hi:[1,0,0]
    v_and_b32 v135, v158, v135
    v_cvt_pk_bf16_f32 v96, v138, v139
    v_fma_mix_f32 v138, v131, v152, -v155 op_sel:[1,0,0] op_sel_hi:[1,0,0]
    v_and_b32 v136, v156, v137
    v_fma_mix_f32 v139, v132, v153, -v155 op_sel:[1,0,0] op_sel_hi:[1,0,0]
    v_cvt_pk_bf16_f32 v97, v140, v141
    v_and_b32 v137, v157, v137
    v_cvt_pk_bf16_f32 v98, v138, v139
    v_fma_mix_f32 v138, v133, v142, -v148 op_sel:[0,0,0] op_sel_hi:[1,0,0]
    v_fma_mix_f32 v139, v134, v143, -v148 op_sel:[0,0,0] op_sel_hi:[1,0,0]
    v_add_u32 v130, v115, v115
    v_fma_mix_f32 v140, v135, v144, -v148 op_sel:[0,0,0] op_sel_hi:[1,0,0]
    v_fma_mix_f32 v141, v136, v142, -v148 op_sel:[0,0,0] op_sel_hi:[1,0,0]
    v_lshrrev_b32 v132, 8, v115
    v_cvt_pk_bf16_f32 v35, v138, v139
    v_fma_mix_f32 v138, v137, v143, -v148 op_sel:[0,0,0] op_sel_hi:[1,0,0]
    v_and_b32 v128, v156, v130
    v_fma_mix_f32 v139, v133, v145, -v148 op_sel:[1,0,0] op_sel_hi:[1,0,0]
    v_cvt_pk_bf16_f32 v36, v140, v141
    v_and_b32 v129, v157, v130
    v_fma_mix_f32 v140, v134, v146, -v148 op_sel:[1,0,0] op_sel_hi:[1,0,0]
    v_fma_mix_f32 v141, v135, v147, -v148 op_sel:[1,0,0] op_sel_hi:[1,0,0]
    v_and_b32 v130, v158, v130
    v_cvt_pk_bf16_f32 v37, v138, v139
    v_fma_mix_f32 v138, v136, v145, -v148 op_sel:[1,0,0] op_sel_hi:[1,0,0]
    v_and_b32 v131, v156, v132
    v_fma_mix_f32 v139, v137, v146, -v148 op_sel:[1,0,0] op_sel_hi:[1,0,0]
    v_cvt_pk_bf16_f32 v38, v140, v141
    v_and_b32 v132, v157, v132
    v_cvt_pk_bf16_f32 v39, v138, v139
    v_fma_mix_f32 v138, v128, v149, -v155 op_sel:[0,0,0] op_sel_hi:[1,0,0]
    v_fma_mix_f32 v139, v129, v150, -v155 op_sel:[0,0,0] op_sel_hi:[1,0,0]
    s_waitcnt lgkmcnt(5)
    v_add_u32 v135, v116, v116
    v_fma_mix_f32 v140, v130, v151, -v155 op_sel:[0,0,0] op_sel_hi:[1,0,0]
    v_fma_mix_f32 v141, v131, v149, -v155 op_sel:[0,0,0] op_sel_hi:[1,0,0]
    v_lshrrev_b32 v137, 8, v116
    v_cvt_pk_bf16_f32 v99, v138, v139
    v_fma_mix_f32 v138, v132, v150, -v155 op_sel:[0,0,0] op_sel_hi:[1,0,0]
    v_and_b32 v133, v156, v135
    v_fma_mix_f32 v139, v128, v152, -v155 op_sel:[1,0,0] op_sel_hi:[1,0,0]
    v_cvt_pk_bf16_f32 v100, v140, v141
    v_and_b32 v134, v157, v135
    v_fma_mix_f32 v140, v129, v153, -v155 op_sel:[1,0,0] op_sel_hi:[1,0,0]
    v_fma_mix_f32 v141, v130, v154, -v155 op_sel:[1,0,0] op_sel_hi:[1,0,0]
    v_and_b32 v135, v158, v135
    v_cvt_pk_bf16_f32 v101, v138, v139
    v_fma_mix_f32 v138, v131, v152, -v155 op_sel:[1,0,0] op_sel_hi:[1,0,0]
    v_and_b32 v136, v156, v137
    v_fma_mix_f32 v139, v132, v153, -v155 op_sel:[1,0,0] op_sel_hi:[1,0,0]
    v_cvt_pk_bf16_f32 v102, v140, v141
    v_and_b32 v137, v157, v137
    v_cvt_pk_bf16_f32 v103, v138, v139
    v_fma_mix_f32 v138, v133, v142, -v148 op_sel:[0,0,0] op_sel_hi:[1,0,0]
    v_fma_mix_f32 v139, v134, v143, -v148 op_sel:[0,0,0] op_sel_hi:[1,0,0]
    v_add_u32 v130, v117, v117
    v_fma_mix_f32 v140, v135, v144, -v148 op_sel:[0,0,0] op_sel_hi:[1,0,0]
    v_fma_mix_f32 v141, v136, v142, -v148 op_sel:[0,0,0] op_sel_hi:[1,0,0]
    v_lshrrev_b32 v132, 8, v117
    v_cvt_pk_bf16_f32 v40, v138, v139
    v_fma_mix_f32 v138, v137, v143, -v148 op_sel:[0,0,0] op_sel_hi:[1,0,0]
    v_and_b32 v128, v156, v130
    v_fma_mix_f32 v139, v133, v145, -v148 op_sel:[1,0,0] op_sel_hi:[1,0,0]
    v_cvt_pk_bf16_f32 v41, v140, v141
    v_and_b32 v129, v157, v130
    v_fma_mix_f32 v140, v134, v146, -v148 op_sel:[1,0,0] op_sel_hi:[1,0,0]
    v_fma_mix_f32 v141, v135, v147, -v148 op_sel:[1,0,0] op_sel_hi:[1,0,0]
    v_and_b32 v130, v158, v130
    v_cvt_pk_bf16_f32 v42, v138, v139
    v_fma_mix_f32 v138, v136, v145, -v148 op_sel:[1,0,0] op_sel_hi:[1,0,0]
    v_and_b32 v131, v156, v132
    v_fma_mix_f32 v139, v137, v146, -v148 op_sel:[1,0,0] op_sel_hi:[1,0,0]
    v_cvt_pk_bf16_f32 v43, v140, v141
    v_and_b32 v132, v157, v132
    v_cvt_pk_bf16_f32 v44, v138, v139
L_pad0:
    s_cbranch_execz L_pad4
    v_fma_mix_f32 v138, v128, v149, -v155 op_sel:[0,0,0] op_sel_hi:[1,0,0]
    v_fma_mix_f32 v139, v129, v150, -v155 op_sel:[0,0,0] op_sel_hi:[1,0,0]
    s_waitcnt lgkmcnt(4)
    v_add_u32 v135, v118, v118
    v_fma_mix_f32 v140, v130, v151, -v155 op_sel:[0,0,0] op_sel_hi:[1,0,0]
    v_fma_mix_f32 v141, v131, v149, -v155 op_sel:[0,0,0] op_sel_hi:[1,0,0]
    v_lshrrev_b32 v137, 8, v118
    v_cvt_pk_bf16_f32 v104, v138, v139
    v_fma_mix_f32 v138, v132, v150, -v155 op_sel:[0,0,0] op_sel_hi:[1,0,0]
    v_and_b32 v133, v156, v135
    v_fma_mix_f32 v139, v128, v152, -v155 op_sel:[1,0,0] op_sel_hi:[1,0,0]
    v_cvt_pk_bf16_f32 v105, v140, v141
    v_and_b32 v134, v157, v135
    v_fma_mix_f32 v140, v129, v153, -v155 op_sel:[1,0,0] op_sel_hi:[1,0,0]
    v_fma_mix_f32 v141, v130, v154, -v155 op_sel:[1,0,0] op_sel_hi:[1,0,0]
    v_and_b32 v135, v158, v135
    v_cvt_pk_bf16_f32 v106, v138, v139
    v_fma_mix_f32 v138, v131, v152, -v155 op_sel:[1,0,0] op_sel_hi:[1,0,0]
    v_and_b32 v136, v156, v137
    v_fma_mix_f32 v139, v132, v153, -v155 op_sel:[1,0,0] op_sel_hi:[1,0,0]
    v_cvt_pk_bf16_f32 v107, v140, v141
    v_and_b32 v137, v157, v137
    v_cvt_pk_bf16_f32 v108, v138, v139
    v_fma_mix_f32 v138, v133, v142, -v148 op_sel:[0,0,0] op_sel_hi:[1,0,0]
    v_fma_mix_f32 v139, v134, v143, -v148 op_sel:[0,0,0] op_sel_hi:[1,0,0]
    v_add_u32 v130, v119, v119
    v_fma_mix_f32 v140, v135, v144, -v148 op_sel:[0,0,0] op_sel_hi:[1,0,0]
    v_fma_mix_f32 v141, v136, v142, -v148 op_sel:[0,0,0] op_sel_hi:[1,0,0]
    v_lshrrev_b32 v132, 8, v119
    s_waitcnt lgkmcnt(0)
    s_barrier
    ds_read_b128 a[0:3], v169 offset:33280
    ds_read_b128 a[4:7], v169 offset:33296
    v_cvt_pk_bf16_f32 v45, v138, v139
    v_fma_mix_f32 v138, v137, v143, -v148 op_sel:[0,0,0] op_sel_hi:[1,0,0]
    ds_read_b128 a[8:11], v169 offset:33312
    v_and_b32 v128, v156, v130
    v_fma_mix_f32 v139, v133, v145, -v148 op_sel:[1,0,0] op_sel_hi:[1,0,0]
    v_cvt_pk_bf16_f32 v46, v140, v141
    ds_read_b128 a[12:15], v169 offset:33328
    v_and_b32 v129, v157, v130
    v_fma_mix_f32 v140, v134, v146, -v148 op_sel:[1,0,0] op_sel_hi:[1,0,0]
    v_fma_mix_f32 v141, v135, v147, -v148 op_sel:[1,0,0] op_sel_hi:[1,0,0]
    v_and_b32 v130, v158, v130
    v_cvt_pk_bf16_f32 v47, v138, v139
    v_fma_mix_f32 v138, v136, v145, -v148 op_sel:[1,0,0] op_sel_hi:[1,0,0]
    v_and_b32 v131, v156, v132
    v_fma_mix_f32 v139, v137, v146, -v148 op_sel:[1,0,0] op_sel_hi:[1,0,0]
    v_cvt_pk_bf16_f32 v48, v140, v141
    v_and_b32 v132, v157, v132
    v_cvt_pk_bf16_f32 v49, v138, v139
    v_fma_mix_f32 v138, v128, v149, -v155 op_sel:[0,0,0] op_sel_hi:[1,0,0]
    v_fma_mix_f32 v139, v129, v150, -v155 op_sel:[0,0,0] op_sel_hi:[1,0,0]
    v_add_u32 v135, v120, v120
    v_fma_mix_f32 v140, v130, v151, -v155 op_sel:[0,0,0] op_sel_hi:[1,0,0]
    v_fma_mix_f32 v141, v131, v149, -v155 op_sel:[0,0,0] op_sel_hi:[1,0,0]
    v_lshrrev_b32 v137, 8, v120
    v_cvt_pk_bf16_f32 v109, v138, v139
    v_fma_mix_f32 v138, v132, v150, -v155 op_sel:[0,0,0] op_sel_hi:[1,0,0]
    v_and_b32 v133, v156, v135
    s_waitcnt lgkmcnt(2)
    v_mfma_f32_16x16x32_bf16 a[32:35], a[0:3], v[0:3], 0
    ds_read_b128 a[16:19], v169 offset:33344
    v_fma_mix_f32 v139, v128, v152, -v155 op_sel:[1,0,0] op_sel_hi:[1,0,0]
    v_mfma_f32_16x16x32_bf16 a[32:35], a[4:7], v[4:7], a[32:35]
    ds_read_b128 a[20:23], v169 offset:33360
    v_cvt_pk_bf16_f32 v110, v140, v141
    s_waitcnt lgkmcnt(2)
    v_mfma_f32_16x16x32_bf16 a[32:35], a[8:11], v[8:11], a[32:35]
    ds_read_b128 a[24:27], v169 offset:33376
    v_and_b32 v134, v157, v135
    v_mfma_f32_16x16x32_bf16 a[32:35], a[12:15], v[12:15], a[32:35]
    ds_read_b128 a[28:31], v169 offset:33392
    v_fma_mix_f32 v140, v129, v153, -v155 op_sel:[1,0,0] op_sel_hi:[1,0,0]
    v_mfma_f32_16x16x32_bf16 a[36:39], a[0:3], v[64:67], 0
    ds_read_b128 a[0:3], v169 offset:33408
    v_fma_mix_f32 v141, v130, v154, -v155 op_sel:[1,0,0] op_sel_hi:[1,0,0]
    v_mfma_f32_16x16x32_bf16 a[36:39], a[4:7], v[68:71], a[36:39]
    ds_read_b128 a[4:7], v169 offset:33424
    v_and_b32 v135, v158, v135
    v_mfma_f32_16x16x32_bf16 a[36:39], a[8:11], v[72:75], a[36:39]
    ds_read_b128 a[8:11], v169 offset:33440
    v_cvt_pk_bf16_f32 v111, v138, v139
    v_mfma_f32_16x16x32_bf16 a[36:39], a[12:15], v[76:79], a[36:39]
    ds_read_b128 a[12:15], v169 offset:33456
    v_fma_mix_f32 v138, v131, v152, -v155 op_sel:[1,0,0] op_sel_hi:[1,0,0]
    s_waitcnt lgkmcnt(6)
    v_mfma_f32_16x16x32_bf16 a[32:35], a[16:19], v[16:19], a[32:35]
    v_and_b32 v136, v156, v137
    v_mfma_f32_16x16x32_bf16 a[32:35], a[20:23], v[20:23], a[32:35]
    v_fma_mix_f32 v139, v132, v153, -v155 op_sel:[1,0,0] op_sel_hi:[1,0,0]
    s_waitcnt lgkmcnt(4)
    v_mfma_f32_16x16x32_bf16 a[32:35], a[24:27], v[24:27], a[32:35]
    v_cvt_pk_bf16_f32 v112, v140, v141
    v_mfma_f32_16x16x32_bf16 a[32:35], a[28:31], v[28:31], a[32:35]
    v_and_b32 v137, v157, v137
    v_mfma_f32_16x16x32_bf16 a[36:39], a[16:19], v[80:83], a[36:39]
    ds_read_b128 a[16:19], v169 offset:49920
    v_cvt_pk_bf16_f32 v113, v138, v139
    v_mfma_f32_16x16x32_bf16 a[36:39], a[20:23], v[84:87], a[36:39]
    ds_read_b128 a[20:23], v169 offset:49936
    v_fma_mix_f32 v138, v133, v142, -v148 op_sel:[0,0,0] op_sel_hi:[1,0,0]
    v_mfma_f32_16x16x32_bf16 a[36:39], a[24:27], v[88:91], a[36:39]
    ds_read_b128 a[24:27], v169 offset:49952
    v_fma_mix_f32 v139, v134, v143, -v148 op_sel:[0,0,0] op_sel_hi:[1,0,0]
    v_mfma_f32_16x16x32_bf16 a[36:39], a[28:31], v[92:95], a[36:39]
    ds_read_b128 a[28:31], v169 offset:49968
    v_add_u32 v130, v121, v121
    s_waitcnt lgkmcnt(6)
    v_mfma_f32_16x16x32_bf16 a[32:35], a[0:3], v[32:35], a[32:35]
    v_fma_mix_f32 v140, v135, v144, -v148 op_sel:[0,0,0] op_sel_hi:[1,0,0]
    v_mfma_f32_16x16x32_bf16 a[32:35], a[4:7], v[36:39], a[32:35]
    v_fma_mix_f32 v141, v136, v142, -v148 op_sel:[0,0,0] op_sel_hi:[1,0,0]
    s_waitcnt lgkmcnt(4)
    v_mfma_f32_16x16x32_bf16 a[32:35], a[8:11], v[40:43], a[32:35]
    v_lshrrev_b32 v132, 8, v121
    v_mfma_f32_16x16x32_bf16 a[32:35], a[12:15], v[44:47], a[32:35]
    v_cvt_pk_bf16_f32 v50, v138, v139
    v_mfma_f32_16x16x32_bf16 a[36:39], a[0:3], v[96:99], a[36:39]
    ds_read_b128 a[0:3], v169 offset:49984
    v_fma_mix_f32 v138, v137, v143, -v148 op_sel:[0,0,0] op_sel_hi:[1,0,0]
    v_mfma_f32_16x16x32_bf16 a[36:39], a[4:7], v[100:103], a[36:39]
    ds_read_b128 a[4:7], v169 offset:50000
    v_and_b32 v128, v156, v130
    v_mfma_f32_16x16x32_bf16 a[36:39], a[8:11], v[104:107], a[36:39]
    ds_read_b128 a[8:11], v169 offset:50016
    v_fma_mix_f32 v139, v133, v145, -v148 op_sel:[1,0,0] op_sel_hi:[1,0,0]
    v_mfma_f32_16x16x32_bf16 a[36:39], a[12:15], v[108:111], a[36:39]
    ds_read_b128 a[12:15], v169 offset:50032
    s_waitcnt lgkmcnt(0)
    s_barrier
    v_mfma_f32_16x16x32_bf16 a[40:43], a[16:19], v[0:3], 0
    v_cvt_pk_bf16_f32 v51, v140, v141
    v_mfma_f32_16x16x32_bf16 a[40:43], a[20:23], v[4:7], a[40:43]
    v_and_b32 v129, v157, v130
    v_mfma_f32_16x16x32_bf16 a[40:43], a[24:27], v[8:11], a[40:43]
    v_fma_mix_f32 v140, v134, v146, -v148 op_sel:[1,0,0] op_sel_hi:[1,0,0]
    v_mfma_f32_16x16x32_bf16 a[40:43], a[28:31], v[12:15], a[40:43]
    v_fma_mix_f32 v141, v135, v147, -v148 op_sel:[1,0,0] op_sel_hi:[1,0,0]
    v_mfma_f32_16x16x32_bf16 a[44:47], a[16:19], v[64:67], 0
    ds_read_b128 a[16:19], v169 offset:50048
    v_and_b32 v130, v158, v130
    v_mfma_f32_16x16x32_bf16 a[44:47], a[20:23], v[68:71], a[44:47]
    ds_read_b128 a[20:23], v169 offset:50064
    v_cvt_pk_bf16_f32 v52, v138, v139
    v_mfma_f32_16x16x32_bf16 a[44:47], a[24:27], v[72:75], a[44:47]
    ds_read_b128 a[24:27], v169 offset:50080
    v_fma_mix_f32 v138, v136, v145, -v148 op_sel:[1,0,0] op_sel_hi:[1,0,0]
    v_mfma_f32_16x16x32_bf16 a[44:47], a[28:31], v[76:79], a[44:47]
    ds_read_b128 a[28:31], v169 offset:50096
    v_and_b32 v131, v156, v132
    v_mfma_f32_16x16x32_bf16 a[40:43], a[0:3], v[16:19], a[40:43]
    v_fma_mix_f32 v139, v137, v146, -v148 op_sel:[1,0,0] op_sel_hi:[1,0,0]
    v_mfma_f32_16x16x32_bf16 a[40:43], a[4:7], v[20:23], a[40:43]
    v_cvt_pk_bf16_f32 v53, v140, v141
    v_mfma_f32_16x16x32_bf16 a[40:43], a[8:11], v[24:27], a[40:43]
    v_and_b32 v132, v157, v132
    v_mfma_f32_16x16x32_bf16 a[40:43], a[12:15], v[28:31], a[40:43]
    v_cvt_pk_bf16_f32 v54, v138, v139
    v_mfma_f32_16x16x32_bf16 a[44:47], a[0:3], v[80:83], a[44:47]
    ds_read_b128 a[0:3], v168 offset:33280
    v_fma_mix_f32 v138, v128, v149, -v155 op_sel:[0,0,0] op_sel_hi:[1,0,0]
    v_mfma_f32_16x16x32_bf16 a[44:47], a[4:7], v[84:87], a[44:47]
    ds_read_b128 a[4:7], v168 offset:33296
    v_fma_mix_f32 v139, v129, v150, -v155 op_sel:[0,0,0] op_sel_hi:[1,0,0]
    v_mfma_f32_16x16x32_bf16 a[44:47], a[8:11], v[88:91], a[44:47]
    ds_read_b128 a[8:11], v168 offset:33312
    v_add_u32 v135, v122, v122
    v_mfma_f32_16x16x32_bf16 a[44:47], a[12:15], v[92:95], a[44:47]
    ds_read_b128 a[12:15], v168 offset:33328
    v_fma_mix_f32 v140, v130, v151, -v155 op_sel:[0,0,0] op_sel_hi:[1,0,0]
    s_waitcnt lgkmcnt(6)
    v_mfma_f32_16x16x32_bf16 a[40:43], a[16:19], v[32:35], a[40:43]
    v_fma_mix_f32 v141, v131, v149, -v155 op_sel:[0,0,0] op_sel_hi:[1,0,0]
    v_mfma_f32_16x16x32_bf16 a[40:43], a[20:23], v[36:39], a[40:43]
    v_lshrrev_b32 v137, 8, v122
    s_waitcnt lgkmcnt(4)
    v_mfma_f32_16x16x32_bf16 a[40:43], a[24:27], v[40:43], a[40:43]
    v_cvt_pk_bf16_f32 v114, v138, v139
    v_mfma_f32_16x16x32_bf16 a[40:43], a[28:31], v[44:47], a[40:43]
    v_fma_mix_f32 v138, v132, v150, -v155 op_sel:[0,0,0] op_sel_hi:[1,0,0]
    v_mfma_f32_16x16x32_bf16 a[44:47], a[16:19], v[96:99], a[44:47]
    ds_read_b128 a[16:19], v168 offset:33344
    v_and_b32 v133, v156, v135
    v_mfma_f32_16x16x32_bf16 a[44:47], a[20:23], v[100:103], a[44:47]
    ds_read_b128 a[20:23], v168 offset:33360
    v_fma_mix_f32 v139, v128, v152, -v155 op_sel:[1,0,0] op_sel_hi:[1,0,0]
    v_mfma_f32_16x16x32_bf16 a[44:47], a[24:27], v[104:107], a[44:47]
    ds_read_b128 a[24:27], v168 offset:33376
    v_cvt_pk_bf16_f32 v115, v140, v141
    v_mfma_f32_16x16x32_bf16 a[44:47], a[28:31], v[108:111], a[44:47]
    ds_read_b128 a[28:31], v168 offset:33392
    v_and_b32 v134, v157, v135
    s_waitcnt lgkmcnt(6)
    v_mfma_f32_16x16x32_bf16 a[48:51], a[0:3], v[0:3], 0
    v_fma_mix_f32 v140, v129, v153, -v155 op_sel:[1,0,0] op_sel_hi:[1,0,0]
    v_mfma_f32_16x16x32_bf16 a[48:51], a[4:7], v[4:7], a[48:51]
    v_fma_mix_f32 v141, v130, v154, -v155 op_sel:[1,0,0] op_sel_hi:[1,0,0]
    s_waitcnt lgkmcnt(4)
    v_mfma_f32_16x16x32_bf16 a[48:51], a[8:11], v[8:11], a[48:51]
    v_and_b32 v135, v158, v135
    v_mfma_f32_16x16x32_bf16 a[48:51], a[12:15], v[12:15], a[48:51]
    v_cvt_pk_bf16_f32 v116, v138, v139
    v_mfma_f32_16x16x32_bf16 a[52:55], a[0:3], v[64:67], 0
    ds_read_b128 a[0:3], v168 offset:33408
    v_fma_mix_f32 v138, v131, v152, -v155 op_sel:[1,0,0] op_sel_hi:[1,0,0]
    v_mfma_f32_16x16x32_bf16 a[52:55], a[4:7], v[68:71], a[52:55]
    ds_read_b128 a[4:7], v168 offset:33424
    v_and_b32 v136, v156, v137
    v_mfma_f32_16x16x32_bf16 a[52:55], a[8:11], v[72:75], a[52:55]
    ds_read_b128 a[8:11], v168 offset:33440
    v_fma_mix_f32 v139, v132, v153, -v155 op_sel:[1,0,0] op_sel_hi:[1,0,0]
    v_mfma_f32_16x16x32_bf16 a[52:55], a[12:15], v[76:79], a[52:55]
    ds_read_b128 a[12:15], v168 offset:33456
    v_cvt_pk_bf16_f32 v117, v140, v141
    s_waitcnt lgkmcnt(6)
    v_mfma_f32_16x16x32_bf16 a[48:51], a[16:19], v[16:19], a[48:51]
    v_and_b32 v137, v157, v137
    v_mfma_f32_16x16x32_bf16 a[48:51], a[20:23], v[20:23], a[48:51]
    v_cvt_pk_bf16_f32 v118, v138, v139
    s_waitcnt lgkmcnt(4)
    v_mfma_f32_16x16x32_bf16 a[48:51], a[24:27], v[24:27], a[48:51]
    v_fma_mix_f32 v138, v133, v142, -v148 op_sel:[0,0,0] op_sel_hi:[1,0,0]
    v_mfma_f32_16x16x32_bf16 a[48:51], a[28:31], v[28:31], a[48:51]
    v_fma_mix_f32 v139, v134, v143, -v148 op_sel:[0,0,0] op_sel_hi:[1,0,0]
    v_mfma_f32_16x16x32_bf16 a[52:55], a[16:19], v[80:83], a[52:55]
    ds_read_b128 a[16:19], v168 offset:49920
    v_add_u32 v130, v123, v123
    v_mfma_f32_16x16x32_bf16 a[52:55], a[20:23], v[84:87], a[52:55]
    ds_read_b128 a[20:23], v168 offset:49936
    v_fma_mix_f32 v140, v135, v144, -v148 op_sel:[0,0,0] op_sel_hi:[1,0,0]
    v_mfma_f32_16x16x32_bf16 a[52:55], a[24:27], v[88:91], a[52:55]
    ds_read_b128 a[24:27], v168 offset:49952
    v_fma_mix_f32 v141, v136, v142, -v148 op_sel:[0,0,0] op_sel_hi:[1,0,0]
    v_mfma_f32_16x16x32_bf16 a[52:55], a[28:31], v[92:95], a[52:55]
    ds_read_b128 a[28:31], v168 offset:49968
    v_lshrrev_b32 v132, 8, v123
    s_waitcnt lgkmcnt(6)
    v_mfma_f32_16x16x32_bf16 a[48:51], a[0:3], v[32:35], a[48:51]
    v_cvt_pk_bf16_f32 v55, v138, v139
    v_mfma_f32_16x16x32_bf16 a[48:51], a[4:7], v[36:39], a[48:51]
    v_fma_mix_f32 v138, v137, v143, -v148 op_sel:[0,0,0] op_sel_hi:[1,0,0]
    s_waitcnt lgkmcnt(4)
    v_mfma_f32_16x16x32_bf16 a[48:51], a[8:11], v[40:43], a[48:51]
    v_and_b32 v128, v156, v130
    v_mfma_f32_16x16x32_bf16 a[48:51], a[12:15], v[44:47], a[48:51]
    v_fma_mix_f32 v139, v133, v145, -v148 op_sel:[1,0,0] op_sel_hi:[1,0,0]
    v_mfma_f32_16x16x32_bf16 a[52:55], a[0:3], v[96:99], a[52:55]
    ds_read_b128 a[0:3], v168 offset:49984
    v_cvt_pk_bf16_f32 v56, v140, v141
    v_mfma_f32_16x16x32_bf16 a[52:55], a[4:7], v[100:103], a[52:55]
    ds_read_b128 a[4:7], v168 offset:50000
    v_and_b32 v129, v157, v130
    v_mfma_f32_16x16x32_bf16 a[52:55], a[8:11], v[104:107], a[52:55]
    ds_read_b128 a[8:11], v168 offset:50016
    v_fma_mix_f32 v140, v134, v146, -v148 op_sel:[1,0,0] op_sel_hi:[1,0,0]
    v_mfma_f32_16x16x32_bf16 a[52:55], a[12:15], v[108:111], a[52:55]
    ds_read_b128 a[12:15], v168 offset:50032
    v_fma_mix_f32 v141, v135, v147, -v148 op_sel:[1,0,0] op_sel_hi:[1,0,0]
    s_waitcnt lgkmcnt(6)
    v_mfma_f32_16x16x32_bf16 a[56:59], a[16:19], v[0:3], 0
    v_and_b32 v130, v158, v130
    v_mfma_f32_16x16x32_bf16 a[56:59], a[20:23], v[4:7], a[56:59]
    v_cvt_pk_bf16_f32 v57, v138, v139
    s_waitcnt lgkmcnt(4)
    v_mfma_f32_16x16x32_bf16 a[56:59], a[24:27], v[8:11], a[56:59]
    v_fma_mix_f32 v138, v136, v145, -v148 op_sel:[1,0,0] op_sel_hi:[1,0,0]
    v_mfma_f32_16x16x32_bf16 a[56:59], a[28:31], v[12:15], a[56:59]
    v_and_b32 v131, v156, v132
    v_mfma_f32_16x16x32_bf16 a[60:63], a[16:19], v[64:67], 0
    ds_read_b128 a[16:19], v168 offset:50048
    v_fma_mix_f32 v139, v137, v146, -v148 op_sel:[1,0,0] op_sel_hi:[1,0,0]
    v_mfma_f32_16x16x32_bf16 a[60:63], a[20:23], v[68:71], a[60:63]
    ds_read_b128 a[20:23], v168 offset:50064
    v_cvt_pk_bf16_f32 v58, v140, v141
    v_mfma_f32_16x16x32_bf16 a[60:63], a[24:27], v[72:75], a[60:63]
    ds_read_b128 a[24:27], v168 offset:50080
    v_and_b32 v132, v157, v132
    v_mfma_f32_16x16x32_bf16 a[60:63], a[28:31], v[76:79], a[60:63]
    ds_read_b128 a[28:31], v168 offset:50096
    v_cvt_pk_bf16_f32 v59, v138, v139
    s_waitcnt lgkmcnt(6)
    v_mfma_f32_16x16x32_bf16 a[56:59], a[0:3], v[16:19], a[56:59]
    v_fma_mix_f32 v138, v128, v149, -v155 op_sel:[0,0,0] op_sel_hi:[1,0,0]
    v_mfma_f32_16x16x32_bf16 a[56:59], a[4:7], v[20:23], a[56:59]
    v_fma_mix_f32 v139, v129, v150, -v155 op_sel:[0,0,0] op_sel_hi:[1,0,0]
    s_waitcnt lgkmcnt(4)
    v_mfma_f32_16x16x32_bf16 a[56:59], a[8:11], v[24:27], a[56:59]
    v_fma_mix_f32 v140, v130, v151, -v155 op_sel:[0,0,0] op_sel_hi:[1,0,0]
    v_mfma_f32_16x16x32_bf16 a[56:59], a[12:15], v[28:31], a[56:59]
    v_fma_mix_f32 v141, v131, v149, -v155 op_sel:[0,0,0] op_sel_hi:[1,0,0]
    v_mfma_f32_16x16x32_bf16 a[60:63], a[0:3], v[80:83], a[60:63]
    ds_read_b128 a[0:3], v169 offset:33472
    v_cvt_pk_bf16_f32 v119, v138, v139
    v_mfma_f32_16x16x32_bf16 a[60:63], a[4:7], v[84:87], a[60:63]
    ds_read_b128 a[4:7], v169 offset:33488
    v_fma_mix_f32 v138, v132, v150, -v155 op_sel:[0,0,0] op_sel_hi:[1,0,0]
    v_mfma_f32_16x16x32_bf16 a[60:63], a[8:11], v[88:91], a[60:63]
    ds_read_b128 a[8:11], v169 offset:33504
    v_fma_mix_f32 v139, v128, v152, -v155 op_sel:[1,0,0] op_sel_hi:[1,0,0]
    v_mfma_f32_16x16x32_bf16 a[60:63], a[12:15], v[92:95], a[60:63]
    ds_read_b128 a[12:15], v169 offset:33520
    v_cvt_pk_bf16_f32 v120, v140, v141
    s_waitcnt lgkmcnt(6)
    v_mfma_f32_16x16x32_bf16 a[56:59], a[16:19], v[32:35], a[56:59]
    v_fma_mix_f32 v140, v129, v153, -v155 op_sel:[1,0,0] op_sel_hi:[1,0,0]
    v_mfma_f32_16x16x32_bf16 a[56:59], a[20:23], v[36:39], a[56:59]
    v_fma_mix_f32 v141, v130, v154, -v155 op_sel:[1,0,0] op_sel_hi:[1,0,0]
    s_waitcnt lgkmcnt(4)
    v_mfma_f32_16x16x32_bf16 a[56:59], a[24:27], v[40:43], a[56:59]
    v_cvt_pk_bf16_f32 v121, v138, v139
    v_mfma_f32_16x16x32_bf16 a[56:59], a[28:31], v[44:47], a[56:59]
    v_fma_mix_f32 v138, v131, v152, -v155 op_sel:[1,0,0] op_sel_hi:[1,0,0]
    v_mfma_f32_16x16x32_bf16 a[60:63], a[16:19], v[96:99], a[60:63]
    ds_read_b128 a[16:19], v169 offset:50112
    v_fma_mix_f32 v139, v132, v153, -v155 op_sel:[1,0,0] op_sel_hi:[1,0,0]
    v_mfma_f32_16x16x32_bf16 a[60:63], a[20:23], v[100:103], a[60:63]
    ds_read_b128 a[20:23], v169 offset:50128
    v_cvt_pk_bf16_f32 v122, v140, v141
    v_mfma_f32_16x16x32_bf16 a[60:63], a[24:27], v[104:107], a[60:63]
    ds_read_b128 a[24:27], v169 offset:50144
    v_cvt_pk_bf16_f32 v123, v138, v139
    v_mfma_f32_16x16x32_bf16 a[60:63], a[28:31], v[108:111], a[60:63]
    ds_read_b128 a[28:31], v169 offset:50160
    v_and_b32 v124, s35, v124
    v_lshrrev_b32 v124, v161, v124
    v_lshl_or_b32 v124, v126, v162, v124
    v_and_b32 v125, s35, v125
    v_lshrrev_b32 v125, v161, v125
    v_lshl_or_b32 v125, v127, v162, v125
    s_waitcnt vmcnt(1)
    s_waitcnt vmcnt(0)
    v_lshlrev_b32 v159, 16, v163
    v_lshlrev_b32 v160, 16, v164
    v_mul_f32 v144, s34, v159
    v_mul_f32 v148, v160, v159
    v_mul_f32 v147, 2.0, v144
    v_mul_f32 v143, 4.0, v147
    v_mul_f32 v146, 2.0, v143
    v_mul_f32 v142, 4.0, v146
    v_mul_f32 v145, 2.0, v142
    v_add_u32 v135, v124, v124
    v_lshrrev_b32 v137, 8, v124
    v_and_b32 v133, v156, v135
    v_and_b32 v134, v157, v135
    v_and_b32 v135, v158, v135
    v_and_b32 v136, v156, v137
    v_and_b32 v137, v157, v137
    v_fma_mix_f32 v138, v133, v142, -v148 op_sel:[0,0,0] op_sel_hi:[1,0,0]
    v_fma_mix_f32 v139, v134, v143, -v148 op_sel:[0,0,0] op_sel_hi:[1,0,0]
    v_add_u32 v130, v125, v125
    v_fma_mix_f32 v140, v135, v144, -v148 op_sel:[0,0,0] op_sel_hi:[1,0,0]
    v_fma_mix_f32 v141, v136, v142, -v148 op_sel:[0,0,0] op_sel_hi:[1,0,0]
    v_lshrrev_b32 v132, 8, v125
    v_cvt_pk_bf16_f32 v60, v138, v139
    v_fma_mix_f32 v138, v137, v143, -v148 op_sel:[0,0,0] op_sel_hi:[1,0,0]
    v_and_b32 v128, v156, v130
    v_fma_mix_f32 v139, v133, v145, -v148 op_sel:[1,0,0] op_sel_hi:[1,0,0]
    v_cvt_pk_bf16_f32 v61, v140, v141
    v_and_b32 v129, v157, v130
    v_fma_mix_f32 v140, v134, v146, -v148 op_sel:[1,0,0] op_sel_hi:[1,0,0]
    v_fma_mix_f32 v141, v135, v147, -v148 op_sel:[1,0,0] op_sel_hi:[1,0,0]
    v_and_b32 v130, v158, v130
    v_cvt_pk_bf16_f32 v62, v138, v139
    v_cvt_pk_bf16_f32 v63, v140, v141
    v_and_b32 v131, v156, v132
    v_and_b32 v132, v157, v132
    v_and_b32 v159, s52, v163
    v_and_b32 v160, s52, v164
    v_mul_f32 v151, s34, v159
    v_mul_f32 v155, v160, v159
    v_mul_f32 v154, 2.0, v151
    v_mul_f32 v150, 4.0, v154
    v_mul_f32 v153, 2.0, v150
    v_mul_f32 v149, 4.0, v153
    v_mul_f32 v152, 2.0, v149
    v_fma_mix_f32 v138, v128, v149, -v155 op_sel:[0,0,0] op_sel_hi:[1,0,0]
    v_fma_mix_f32 v139, v129, v150, -v155 op_sel:[0,0,0] op_sel_hi:[1,0,0]
    v_fma_mix_f32 v140, v130, v151, -v155 op_sel:[0,0,0] op_sel_hi:[1,0,0]
    v_fma_mix_f32 v141, v131, v149, -v155 op_sel:[0,0,0] op_sel_hi:[1,0,0]
    v_cvt_pk_bf16_f32 v124, v138, v139
    v_fma_mix_f32 v138, v132, v150, -v155 op_sel:[0,0,0] op_sel_hi:[1,0,0]
    v_fma_mix_f32 v139, v128, v152, -v155 op_sel:[1,0,0] op_sel_hi:[1,0,0]
    v_cvt_pk_bf16_f32 v125, v140, v141
    v_fma_mix_f32 v140, v129, v153, -v155 op_sel:[1,0,0] op_sel_hi:[1,0,0]
    v_fma_mix_f32 v141, v130, v154, -v155 op_sel:[1,0,0] op_sel_hi:[1,0,0]
    v_cvt_pk_bf16_f32 v126, v138, v139
    v_cvt_pk_bf16_f32 v127, v140, v141
    s_waitcnt lgkmcnt(6)
    v_mfma_f32_16x16x32_bf16 a[32:35], a[0:3], v[48:51], a[32:35]
    v_mfma_f32_16x16x32_bf16 a[32:35], a[4:7], v[52:55], a[32:35]
    s_waitcnt lgkmcnt(4)
    v_mfma_f32_16x16x32_bf16 a[32:35], a[8:11], v[56:59], a[32:35]
    v_mfma_f32_16x16x32_bf16 a[32:35], a[12:15], v[60:63], a[32:35]
    v_mfma_f32_16x16x32_bf16 a[36:39], a[0:3], v[112:115], a[36:39]
    ds_read_b128 a[0:3], v168 offset:33472
    v_mfma_f32_16x16x32_bf16 a[36:39], a[4:7], v[116:119], a[36:39]
    ds_read_b128 a[4:7], v168 offset:33488
    v_mfma_f32_16x16x32_bf16 a[36:39], a[8:11], v[120:123], a[36:39]
    ds_read_b128 a[8:11], v168 offset:33504
    v_mfma_f32_16x16x32_bf16 a[36:39], a[12:15], v[124:127], a[36:39]
    ds_read_b128 a[12:15], v168 offset:33520
    s_waitcnt lgkmcnt(6)
    v_mfma_f32_16x16x32_bf16 a[40:43], a[16:19], v[48:51], a[40:43]
    v_mfma_f32_16x16x32_bf16 a[40:43], a[20:23], v[52:55], a[40:43]
    s_waitcnt lgkmcnt(4)
    v_mfma_f32_16x16x32_bf16 a[40:43], a[24:27], v[56:59], a[40:43]
    v_mfma_f32_16x16x32_bf16 a[40:43], a[28:31], v[60:63], a[40:43]
    v_mfma_f32_16x16x32_bf16 a[44:47], a[16:19], v[112:115], a[44:47]
    ds_read_b128 a[16:19], v168 offset:50112
    v_mfma_f32_16x16x32_bf16 a[44:47], a[20:23], v[116:119], a[44:47]
    ds_read_b128 a[20:23], v168 offset:50128
    v_mfma_f32_16x16x32_bf16 a[44:47], a[24:27], v[120:123], a[44:47]
    ds_read_b128 a[24:27], v168 offset:50144
    v_mfma_f32_16x16x32_bf16 a[44:47], a[28:31], v[124:127], a[44:47]
    ds_read_b128 a[28:31], v168 offset:50160
    s_waitcnt lgkmcnt(6)
    v_mfma_f32_16x16x32_bf16 a[48:51], a[0:3], v[48:51], a[48:51]
    v_mfma_f32_16x16x32_bf16 a[48:51], a[4:7], v[52:55], a[48:51]
    s_waitcnt lgkmcnt(4)
    v_mfma_f32_16x16x32_bf16 a[48:51], a[8:11], v[56:59], a[48:51]
    v_mfma_f32_16x16x32_bf16 a[48:51], a[12:15], v[60:63], a[48:51]
    s_waitcnt lgkmcnt(0)
    s_barrier
    s_add_u32 s58, s39, 4
    s_sub_u32 s51, s58, 7
    s_min_u32 s58, s58, s51
    s_mul_i32 s58, s58, 65280
    s_add_u32 s58, s58, s43
    s_add_u32 m0, s42, 33280
    v_mfma_f32_16x16x32_bf16 a[52:55], a[0:3], v[112:115], a[52:55]
    buffer_load_dwordx4 v170, s[8:11], s58 offen lds
    v_mfma_f32_16x16x32_bf16 a[52:55], a[4:7], v[116:119], a[52:55]
    ds_read_b128 a[0:3], v169 offset:0
    v_mfma_f32_16x16x32_bf16 a[52:55], a[8:11], v[120:123], a[52:55]
    ds_read_b128 a[4:7], v169 offset:16
    v_mfma_f32_16x16x32_bf16 a[52:55], a[12:15], v[124:127], a[52:55]
    ds_read_b128 a[8:11], v169 offset:32
    v_mfma_f32_16x16x32_bf16 a[56:59], a[16:19], v[48:51], a[56:59]
    ds_read_b128 a[12:15], v169 offset:48
    s_add_u32 s51, s58, 2040
    s_add_u32 m0, s42, 34320
    v_mfma_f32_16x16x32_bf16 a[56:59], a[20:23], v[52:55], a[56:59]
    buffer_load_dwordx4 v170, s[8:11], s51 offen lds
    v_mfma_f32_16x16x32_bf16 a[56:59], a[24:27], v[56:59], a[56:59]
    v_mfma_f32_16x16x32_bf16 a[56:59], a[28:31], v[60:63], a[56:59]
    v_mfma_f32_16x16x32_bf16 a[60:63], a[16:19], v[112:115], a[60:63]
    ds_read_b128 a[16:19], v169 offset:64
    v_mfma_f32_16x16x32_bf16 a[60:63], a[20:23], v[116:119], a[60:63]
    ds_read_b128 a[20:23], v169 offset:80
    v_mfma_f32_16x16x32_bf16 a[60:63], a[24:27], v[120:123], a[60:63]
    ds_read_b128 a[24:27], v169 offset:96
    v_mfma_f32_16x16x32_bf16 a[60:63], a[28:31], v[124:127], a[60:63]
    ds_read_b128 a[28:31], v169 offset:112
    s_add_u32 s51, s58, 4080
    s_add_u32 m0, s42, 35360
    s_waitcnt lgkmcnt(6)
    v_mfma_f32_16x16x32_bf16 a[64:67], a[0:3], v[0:3], 0
    buffer_load_dwordx4 v170, s[8:11], s51 offen lds
    v_mfma_f32_16x16x32_bf16 a[64:67], a[4:7], v[4:7], a[64:67]
    s_waitcnt lgkmcnt(4)
    v_mfma_f32_16x16x32_bf16 a[64:67], a[8:11], v[8:11], a[64:67]
    v_mfma_f32_16x16x32_bf16 a[64:67], a[12:15], v[12:15], a[64:67]
    v_mfma_f32_16x16x32_bf16 a[68:71], a[0:3], v[64:67], 0
    ds_read_b128 a[0:3], v169 offset:128
    v_mfma_f32_16x16x32_bf16 a[68:71], a[4:7], v[68:71], a[68:71]
    ds_read_b128 a[4:7], v169 offset:144
    v_mfma_f32_16x16x32_bf16 a[68:71], a[8:11], v[72:75], a[68:71]
    ds_read_b128 a[8:11], v169 offset:160
    v_mfma_f32_16x16x32_bf16 a[68:71], a[12:15], v[76:79], a[68:71]
    ds_read_b128 a[12:15], v169 offset:176
    s_add_u32 s51, s58, 6120
    s_add_u32 m0, s42, 36400
    s_waitcnt lgkmcnt(6)
    v_mfma_f32_16x16x32_bf16 a[64:67], a[16:19], v[16:19], a[64:67]
    buffer_load_dwordx4 v170, s[8:11], s51 offen lds
    v_mfma_f32_16x16x32_bf16 a[64:67], a[20:23], v[20:23], a[64:67]
    s_waitcnt lgkmcnt(4)
    v_mfma_f32_16x16x32_bf16 a[64:67], a[24:27], v[24:27], a[64:67]
    v_mfma_f32_16x16x32_bf16 a[64:67], a[28:31], v[28:31], a[64:67]
    v_mfma_f32_16x16x32_bf16 a[68:71], a[16:19], v[80:83], a[68:71]
    ds_read_b128 a[16:19], v169 offset:192
    v_mfma_f32_16x16x32_bf16 a[68:71], a[20:23], v[84:87], a[68:71]
    ds_read_b128 a[20:23], v169 offset:208
    v_mfma_f32_16x16x32_bf16 a[68:71], a[24:27], v[88:91], a[68:71]
    ds_read_b128 a[24:27], v169 offset:224
    v_mfma_f32_16x16x32_bf16 a[68:71], a[28:31], v[92:95], a[68:71]
    ds_read_b128 a[28:31], v169 offset:240
    s_add_u32 s51, s58, 8160
    s_add_u32 m0, s42, 37440
    s_waitcnt lgkmcnt(6)
    v_mfma_f32_16x16x32_bf16 a[64:67], a[0:3], v[32:35], a[64:67]
    buffer_load_dwordx4 v170, s[8:11], s51 offen lds
    v_mfma_f32_16x16x32_bf16 a[64:67], a[4:7], v[36:39], a[64:67]
    s_waitcnt lgkmcnt(4)
    v_mfma_f32_16x16x32_bf16 a[64:67], a[8:11], v[40:43], a[64:67]
    v_mfma_f32_16x16x32_bf16 a[64:67], a[12:15], v[44:47], a[64:67]
    v_mfma_f32_16x16x32_bf16 a[68:71], a[0:3], v[96:99], a[68:71]
    ds_read_b128 a[0:3], v169 offset:16640
    v_mfma_f32_16x16x32_bf16 a[68:71], a[4:7], v[100:103], a[68:71]
    ds_read_b128 a[4:7], v169 offset:16656
    v_mfma_f32_16x16x32_bf16 a[68:71], a[8:11], v[104:107], a[68:71]
    ds_read_b128 a[8:11], v169 offset:16672
    v_mfma_f32_16x16x32_bf16 a[68:71], a[12:15], v[108:111], a[68:71]
    ds_read_b128 a[12:15], v169 offset:16688
    s_add_u32 s51, s58, 10200
    s_add_u32 m0, s42, 38480
    s_waitcnt lgkmcnt(6)
    v_mfma_f32_16x16x32_bf16 a[64:67], a[16:19], v[48:51], a[64:67]
    buffer_load_dwordx4 v170, s[8:11], s51 offen lds
    v_mfma_f32_16x16x32_bf16 a[64:67], a[20:23], v[52:55], a[64:67]
    s_waitcnt lgkmcnt(4)
    v_mfma_f32_16x16x32_bf16 a[64:67], a[24:27], v[56:59], a[64:67]
    v_mfma_f32_16x16x32_bf16 a[64:67], a[28:31], v[60:63], a[64:67]
    v_mfma_f32_16x16x32_bf16 a[68:71], a[16:19], v[112:115], a[68:71]
    ds_read_b128 a[16:19], v169 offset:16704
    v_mfma_f32_16x16x32_bf16 a[68:71], a[20:23], v[116:119], a[68:71]
    ds_read_b128 a[20:23], v169 offset:16720
    v_mfma_f32_16x16x32_bf16 a[68:71], a[24:27], v[120:123], a[68:71]
    ds_read_b128 a[24:27], v169 offset:16736
    v_mfma_f32_16x16x32_bf16 a[68:71], a[28:31], v[124:127], a[68:71]
    ds_read_b128 a[28:31], v169 offset:16752
    s_add_u32 s51, s58, 12240
    s_add_u32 m0, s42, 39520
    s_waitcnt lgkmcnt(6)
    v_mfma_f32_16x16x32_bf16 a[72:75], a[0:3], v[0:3], 0
    buffer_load_dwordx4 v170, s[8:11], s51 offen lds
    v_mfma_f32_16x16x32_bf16 a[72:75], a[4:7], v[4:7], a[72:75]
    s_waitcnt lgkmcnt(4)
    v_mfma_f32_16x16x32_bf16 a[72:75], a[8:11], v[8:11], a[72:75]
    v_mfma_f32_16x16x32_bf16 a[72:75], a[12:15], v[12:15], a[72:75]
    v_mfma_f32_16x16x32_bf16 a[76:79], a[0:3], v[64:67], 0
    ds_read_b128 a[0:3], v169 offset:16768
    v_mfma_f32_16x16x32_bf16 a[76:79], a[4:7], v[68:71], a[76:79]
    ds_read_b128 a[4:7], v169 offset:16784
    v_mfma_f32_16x16x32_bf16 a[76:79], a[8:11], v[72:75], a[76:79]
    ds_read_b128 a[8:11], v169 offset:16800
    v_mfma_f32_16x16x32_bf16 a[76:79], a[12:15], v[76:79], a[76:79]
    ds_read_b128 a[12:15], v169 offset:16816
    s_add_u32 s51, s58, 14280
    s_add_u32 m0, s42, 40560
    s_waitcnt lgkmcnt(6)
    v_mfma_f32_16x16x32_bf16 a[72:75], a[16:19], v[16:19], a[72:75]
    buffer_load_dwordx4 v170, s[8:11], s51 offen lds
    v_mfma_f32_16x16x32_bf16 a[72:75], a[20:23], v[20:23], a[72:75]
    s_waitcnt lgkmcnt(4)
    v_mfma_f32_16x16x32_bf16 a[72:75], a[24:27], v[24:27], a[72:75]
    v_mfma_f32_16x16x32_bf16 a[72:75], a[28:31], v[28:31], a[72:75]
    v_mfma_f32_16x16x32_bf16 a[76:79], a[16:19], v[80:83], a[76:79]
    ds_read_b128 a[16:19], v169 offset:16832
    v_mfma_f32_16x16x32_bf16 a[76:79], a[20:23], v[84:87], a[76:79]
    ds_read_b128 a[20:23], v169 offset:16848
    v_mfma_f32_16x16x32_bf16 a[76:79], a[24:27], v[88:91], a[76:79]
    ds_read_b128 a[24:27], v169 offset:16864
    v_mfma_f32_16x16x32_bf16 a[76:79], a[28:31], v[92:95], a[76:79]
    ds_read_b128 a[28:31], v169 offset:16880
    s_waitcnt lgkmcnt(6)
    v_mfma_f32_16x16x32_bf16 a[72:75], a[0:3], v[32:35], a[72:75]
    v_mfma_f32_16x16x32_bf16 a[72:75], a[4:7], v[36:39], a[72:75]
    s_waitcnt lgkmcnt(4)
    v_mfma_f32_16x16x32_bf16 a[72:75], a[8:11], v[40:43], a[72:75]
    v_mfma_f32_16x16x32_bf16 a[72:75], a[12:15], v[44:47], a[72:75]
    s_waitcnt lgkmcnt(0)
    s_barrier
    v_mfma_f32_16x16x32_bf16 a[76:79], a[0:3], v[96:99], a[76:79]
    ds_read_b128 a[0:3], v168 offset:0
    v_mfma_f32_16x16x32_bf16 a[76:79], a[4:7], v[100:103], a[76:79]
    ds_read_b128 a[4:7], v168 offset:16
    v_mfma_f32_16x16x32_bf16 a[76:79], a[8:11], v[104:107], a[76:79]
    ds_read_b128 a[8:11], v168 offset:32
    v_mfma_f32_16x16x32_bf16 a[76:79], a[12:15], v[108:111], a[76:79]
    ds_read_b128 a[12:15], v168 offset:48
    v_mfma_f32_16x16x32_bf16 a[72:75], a[16:19], v[48:51], a[72:75]
    v_mfma_f32_16x16x32_bf16 a[72:75], a[20:23], v[52:55], a[72:75]
    ds_write_b128 v172, a[32:35] offset:0
    v_mfma_f32_16x16x32_bf16 a[72:75], a[24:27], v[56:59], a[72:75]
    v_mfma_f32_16x16x32_bf16 a[72:75], a[28:31], v[60:63], a[72:75]
    v_mfma_f32_16x16x32_bf16 a[76:79], a[16:19], v[112:115], a[76:79]
L_pad1:
    s_cbranch_execz L_pad5
    ds_read_b128 a[16:19], v168 offset:64
    v_mfma_f32_16x16x32_bf16 a[76:79], a[20:23], v[116:119], a[76:79]
    ds_read_b128 a[20:23], v168 offset:80
    v_mfma_f32_16x16x32_bf16 a[76:79], a[24:27], v[120:123], a[76:79]
    ds_read_b128 a[24:27], v168 offset:96
    v_mfma_f32_16x16x32_bf16 a[76:79], a[28:31], v[124:127], a[76:79]
    ds_read_b128 a[28:31], v168 offset:112
    s_waitcnt lgkmcnt(7)
    v_mfma_f32_16x16x32_bf16 v[128:131], a[0:3], v[0:3], 0
    ds_write_b128 v172, a[36:39] offset:1024
    v_mfma_f32_16x16x32_bf16 v[128:131], a[4:7], v[4:7], v[128:131]
    s_waitcnt lgkmcnt(6)
    v_mfma_f32_16x16x32_bf16 v[128:131], a[8:11], v[8:11], v[128:131]
    v_mfma_f32_16x16x32_bf16 v[128:131], a[12:15], v[12:15], v[128:131]
    v_mfma_f32_16x16x32_bf16 v[132:135], a[0:3], v[64:67], 0
    ds_read_b128 a[0:3], v168 offset:128
    v_mfma_f32_16x16x32_bf16 v[132:135], a[4:7], v[68:71], v[132:135]
    ds_read_b128 a[4:7], v168 offset:144
    v_mfma_f32_16x16x32_bf16 v[132:135], a[8:11], v[72:75], v[132:135]
    ds_read_b128 a[8:11], v168 offset:160
    v_mfma_f32_16x16x32_bf16 v[132:135], a[12:15], v[76:79], v[132:135]
    ds_read_b128 a[12:15], v168 offset:176
    s_waitcnt lgkmcnt(7)
    v_mfma_f32_16x16x32_bf16 v[128:131], a[16:19], v[16:19], v[128:131]
    ds_write_b128 v172, a[40:43] offset:2048
    v_mfma_f32_16x16x32_bf16 v[128:131], a[20:23], v[20:23], v[128:131]
    s_waitcnt lgkmcnt(6)
    v_mfma_f32_16x16x32_bf16 v[128:131], a[24:27], v[24:27], v[128:131]
    v_mfma_f32_16x16x32_bf16 v[128:131], a[28:31], v[28:31], v[128:131]
    v_mfma_f32_16x16x32_bf16 v[132:135], a[16:19], v[80:83], v[132:135]
    ds_read_b128 a[16:19], v168 offset:192
    v_mfma_f32_16x16x32_bf16 v[132:135], a[20:23], v[84:87], v[132:135]
    ds_read_b128 a[20:23], v168 offset:208
    v_mfma_f32_16x16x32_bf16 v[132:135], a[24:27], v[88:91], v[132:135]
    ds_read_b128 a[24:27], v168 offset:224
    v_mfma_f32_16x16x32_bf16 v[132:135], a[28:31], v[92:95], v[132:135]
    ds_read_b128 a[28:31], v168 offset:240
    s_waitcnt lgkmcnt(7)
    v_mfma_f32_16x16x32_bf16 v[128:131], a[0:3], v[32:35], v[128:131]
    ds_write_b128 v172, a[44:47] offset:3072
    v_mfma_f32_16x16x32_bf16 v[128:131], a[4:7], v[36:39], v[128:131]
    s_waitcnt lgkmcnt(6)
    v_mfma_f32_16x16x32_bf16 v[128:131], a[8:11], v[40:43], v[128:131]
    s_add_u32 s59, s39, 5
    s_sub_u32 s51, s59, 7
    s_min_u32 s59, s59, s51
    s_mul_i32 s59, s59, 65280
    s_add_u32 s59, s59, s43
    s_add_u32 m0, s42, 66560
    v_mfma_f32_16x16x32_bf16 v[128:131], a[12:15], v[44:47], v[128:131]
    buffer_load_dwordx4 v170, s[8:11], s59 offen lds
    v_mfma_f32_16x16x32_bf16 v[132:135], a[0:3], v[96:99], v[132:135]
    ds_read_b128 a[0:3], v168 offset:16640
    v_mfma_f32_16x16x32_bf16 v[132:135], a[4:7], v[100:103], v[132:135]
    ds_read_b128 a[4:7], v168 offset:16656
    v_mfma_f32_16x16x32_bf16 v[132:135], a[8:11], v[104:107], v[132:135]
    ds_read_b128 a[8:11], v168 offset:16672
    v_mfma_f32_16x16x32_bf16 v[132:135], a[12:15], v[108:111], v[132:135]
    ds_read_b128 a[12:15], v168 offset:16688
    s_add_u32 s51, s59, 2040
    s_add_u32 m0, s42, 67600
    s_waitcnt lgkmcnt(7)
    v_mfma_f32_16x16x32_bf16 v[128:131], a[16:19], v[48:51], v[128:131]
    buffer_load_dwordx4 v170, s[8:11], s51 offen lds
    v_mfma_f32_16x16x32_bf16 v[128:131], a[20:23], v[52:55], v[128:131]
    s_add_u32 s51, s59, 4080
    s_add_u32 m0, s42, 68640
    s_waitcnt lgkmcnt(5)
    v_mfma_f32_16x16x32_bf16 v[128:131], a[24:27], v[56:59], v[128:131]
    buffer_load_dwordx4 v170, s[8:11], s51 offen lds
    v_mfma_f32_16x16x32_bf16 v[128:131], a[28:31], v[60:63], v[128:131]
    v_mfma_f32_16x16x32_bf16 v[132:135], a[16:19], v[112:115], v[132:135]
    ds_read_b128 a[16:19], v168 offset:16704
    v_mfma_f32_16x16x32_bf16 v[132:135], a[20:23], v[116:119], v[132:135]
    ds_read_b128 a[20:23], v168 offset:16720
    v_mfma_f32_16x16x32_bf16 v[132:135], a[24:27], v[120:123], v[132:135]
    ds_read_b128 a[24:27], v168 offset:16736
    v_mfma_f32_16x16x32_bf16 v[132:135], a[28:31], v[124:127], v[132:135]
    ds_read_b128 a[28:31], v168 offset:16752
    s_add_u32 s51, s59, 6120
    s_add_u32 m0, s42, 69680
    s_waitcnt lgkmcnt(6)
    v_mfma_f32_16x16x32_bf16 v[136:139], a[0:3], v[0:3], 0
    buffer_load_dwordx4 v170, s[8:11], s51 offen lds
    v_mfma_f32_16x16x32_bf16 v[136:139], a[4:7], v[4:7], v[136:139]
    s_add_u32 s51, s59, 8160
    s_add_u32 m0, s42, 70720
    s_waitcnt lgkmcnt(4)
    v_mfma_f32_16x16x32_bf16 v[136:139], a[8:11], v[8:11], v[136:139]
    buffer_load_dwordx4 v170, s[8:11], s51 offen lds
    v_mfma_f32_16x16x32_bf16 v[136:139], a[12:15], v[12:15], v[136:139]
    v_mfma_f32_16x16x32_bf16 v[140:143], a[0:3], v[64:67], 0
    ds_read_b128 a[0:3], v168 offset:16768
    v_mfma_f32_16x16x32_bf16 v[140:143], a[4:7], v[68:71], v[140:143]
    ds_read_b128 a[4:7], v168 offset:16784
    v_mfma_f32_16x16x32_bf16 v[140:143], a[8:11], v[72:75], v[140:143]
    ds_read_b128 a[8:11], v168 offset:16800
    v_mfma_f32_16x16x32_bf16 v[140:143], a[12:15], v[76:79], v[140:143]
    ds_read_b128 a[12:15], v168 offset:16816
    s_add_u32 s51, s59, 10200
    s_add_u32 m0, s42, 71760
    s_waitcnt lgkmcnt(6)
    v_mfma_f32_16x16x32_bf16 v[136:139], a[16:19], v[16:19], v[136:139]
    buffer_load_dwordx4 v170, s[8:11], s51 offen lds
    v_mfma_f32_16x16x32_bf16 v[136:139], a[20:23], v[20:23], v[136:139]
    s_add_u32 s51, s59, 12240
    s_add_u32 m0, s42, 72800
    s_waitcnt lgkmcnt(4)
    v_mfma_f32_16x16x32_bf16 v[136:139], a[24:27], v[24:27], v[136:139]
    buffer_load_dwordx4 v170, s[8:11], s51 offen lds
    v_mfma_f32_16x16x32_bf16 v[136:139], a[28:31], v[28:31], v[136:139]
    v_mfma_f32_16x16x32_bf16 v[140:143], a[16:19], v[80:83], v[140:143]
    ds_read_b128 a[16:19], v168 offset:16832
    v_mfma_f32_16x16x32_bf16 v[140:143], a[20:23], v[84:87], v[140:143]
    ds_read_b128 a[20:23], v168 offset:16848
    v_mfma_f32_16x16x32_bf16 v[140:143], a[24:27], v[88:91], v[140:143]
    ds_read_b128 a[24:27], v168 offset:16864
    v_mfma_f32_16x16x32_bf16 v[140:143], a[28:31], v[92:95], v[140:143]
    ds_read_b128 a[28:31], v168 offset:16880
    s_add_u32 s51, s59, 14280
    s_add_u32 m0, s42, 73840
    s_waitcnt lgkmcnt(6)
    v_mfma_f32_16x16x32_bf16 v[136:139], a[0:3], v[32:35], v[136:139]
    buffer_load_dwordx4 v170, s[8:11], s51 offen lds
    v_mfma_f32_16x16x32_bf16 v[136:139], a[4:7], v[36:39], v[136:139]
    s_waitcnt lgkmcnt(4)
    v_mfma_f32_16x16x32_bf16 v[136:139], a[8:11], v[40:43], v[136:139]
    v_mfma_f32_16x16x32_bf16 v[136:139], a[12:15], v[44:47], v[136:139]
    s_waitcnt vmcnt(8) lgkmcnt(0)
    s_barrier
    v_mfma_f32_16x16x32_bf16 v[140:143], a[0:3], v[96:99], v[140:143]
    ds_read_b128 a[0:3], v168 offset:33280
    v_mfma_f32_16x16x32_bf16 v[140:143], a[4:7], v[100:103], v[140:143]
    ds_read_b128 a[4:7], v168 offset:33296
    v_mfma_f32_16x16x32_bf16 v[140:143], a[8:11], v[104:107], v[140:143]
    ds_read_b128 a[8:11], v168 offset:33312
    v_mfma_f32_16x16x32_bf16 v[140:143], a[12:15], v[108:111], v[140:143]
    ds_read_b128 a[12:15], v168 offset:33328
    s_add_u32 s60, s39, 6
    s_sub_u32 s51, s60, 7
    s_min_u32 s60, s60, s51
    s_mul_i32 s60, s60, 65280
    s_add_u32 s60, s60, s43
    s_add_u32 m0, s42, 0
    v_mfma_f32_16x16x32_bf16 v[136:139], a[16:19], v[48:51], v[136:139]
    buffer_load_dwordx4 v170, s[8:11], s60 offen lds
    v_mfma_f32_16x16x32_bf16 v[136:139], a[20:23], v[52:55], v[136:139]
    v_mfma_f32_16x16x32_bf16 v[136:139], a[24:27], v[56:59], v[136:139]
    v_mfma_f32_16x16x32_bf16 v[136:139], a[28:31], v[60:63], v[136:139]
    v_mfma_f32_16x16x32_bf16 v[140:143], a[16:19], v[112:115], v[140:143]
    ds_read_b128 a[16:19], v168 offset:33344
    v_mfma_f32_16x16x32_bf16 v[140:143], a[20:23], v[116:119], v[140:143]
    ds_read_b128 a[20:23], v168 offset:33360
    v_mfma_f32_16x16x32_bf16 v[140:143], a[24:27], v[120:123], v[140:143]
    ds_read_b128 a[24:27], v168 offset:33376
    v_mfma_f32_16x16x32_bf16 v[140:143], a[28:31], v[124:127], v[140:143]
    ds_read_b128 a[28:31], v168 offset:33392
    s_add_u32 s51, s60, 2040
    s_add_u32 m0, s42, 1040
    s_waitcnt lgkmcnt(6)
    v_mfma_f32_16x16x32_bf16 v[144:147], a[0:3], v[0:3], 0
    buffer_load_dwordx4 v170, s[8:11], s51 offen lds
    v_mfma_f32_16x16x32_bf16 v[144:147], a[4:7], v[4:7], v[144:147]
    s_waitcnt lgkmcnt(4)
    v_mfma_f32_16x16x32_bf16 v[144:147], a[8:11], v[8:11], v[144:147]
    v_mfma_f32_16x16x32_bf16 v[144:147], a[12:15], v[12:15], v[144:147]
    v_mfma_f32_16x16x32_bf16 v[148:151], a[0:3], v[64:67], 0
    ds_read_b128 a[0:3], v168 offset:33408
    v_mfma_f32_16x16x32_bf16 v[148:151], a[4:7], v[68:71], v[148:151]
    ds_read_b128 a[4:7], v168 offset:33424
    v_mfma_f32_16x16x32_bf16 v[148:151], a[8:11], v[72:75], v[148:151]
    ds_read_b128 a[8:11], v168 offset:33440
    v_mfma_f32_16x16x32_bf16 v[148:151], a[12:15], v[76:79], v[148:151]
    ds_read_b128 a[12:15], v168 offset:33456
    s_add_u32 s51, s60, 4080
    s_add_u32 m0, s42, 2080
    s_waitcnt lgkmcnt(6)
    v_mfma_f32_16x16x32_bf16 v[144:147], a[16:19], v[16:19], v[144:147]
    buffer_load_dwordx4 v170, s[8:11], s51 offen lds
    v_mfma_f32_16x16x32_bf16 v[144:147], a[20:23], v[20:23], v[144:147]
    s_waitcnt lgkmcnt(4)
    v_mfma_f32_16x16x32_bf16 v[144:147], a[24:27], v[24:27], v[144:147]
    v_mfma_f32_16x16x32_bf16 v[144:147], a[28:31], v[28:31], v[144:147]
    v_mfma_f32_16x16x32_bf16 v[148:151], a[16:19], v[80:83], v[148:151]
    ds_read_b128 a[16:19], v168 offset:33472
    v_mfma_f32_16x16x32_bf16 v[148:151], a[20:23], v[84:87], v[148:151]
    ds_read_b128 a[20:23], v168 offset:33488
    v_mfma_f32_16x16x32_bf16 v[148:151], a[24:27], v[88:91], v[148:151]
    ds_read_b128 a[24:27], v168 offset:33504
    v_mfma_f32_16x16x32_bf16 v[148:151], a[28:31], v[92:95], v[148:151]
    ds_read_b128 a[28:31], v168 offset:33520
    s_add_u32 s51, s60, 6120
    s_add_u32 m0, s42, 3120
    s_waitcnt lgkmcnt(6)
    v_mfma_f32_16x16x32_bf16 v[144:147], a[0:3], v[32:35], v[144:147]
    buffer_load_dwordx4 v170, s[8:11], s51 offen lds
    v_mfma_f32_16x16x32_bf16 v[144:147], a[4:7], v[36:39], v[144:147]
    s_waitcnt lgkmcnt(4)
    v_mfma_f32_16x16x32_bf16 v[144:147], a[8:11], v[40:43], v[144:147]
    v_mfma_f32_16x16x32_bf16 v[144:147], a[12:15], v[44:47], v[144:147]
    v_mfma_f32_16x16x32_bf16 v[148:151], a[0:3], v[96:99], v[148:151]
    ds_read_b128 a[0:3], v168 offset:49920
    v_mfma_f32_16x16x32_bf16 v[148:151], a[4:7], v[100:103], v[148:151]
    ds_read_b128 a[4:7], v168 offset:49936
    v_mfma_f32_16x16x32_bf16 v[148:151], a[8:11], v[104:107], v[148:151]
    ds_read_b128 a[8:11], v168 offset:49952
    v_mfma_f32_16x16x32_bf16 v[148:151], a[12:15], v[108:111], v[148:151]
    ds_read_b128 a[12:15], v168 offset:49968
    s_add_u32 s51, s60, 8160
    s_add_u32 m0, s42, 4160
    s_waitcnt lgkmcnt(6)
    v_mfma_f32_16x16x32_bf16 v[144:147], a[16:19], v[48:51], v[144:147]
    buffer_load_dwordx4 v170, s[8:11], s51 offen lds
    v_mfma_f32_16x16x32_bf16 v[144:147], a[20:23], v[52:55], v[144:147]
    s_waitcnt lgkmcnt(4)
    v_mfma_f32_16x16x32_bf16 v[144:147], a[24:27], v[56:59], v[144:147]
    v_mfma_f32_16x16x32_bf16 v[144:147], a[28:31], v[60:63], v[144:147]
    v_mfma_f32_16x16x32_bf16 v[148:151], a[16:19], v[112:115], v[148:151]
    ds_read_b128 a[16:19], v168 offset:49984
    v_mfma_f32_16x16x32_bf16 v[148:151], a[20:23], v[116:119], v[148:151]
    ds_read_b128 a[20:23], v168 offset:50000
    v_mfma_f32_16x16x32_bf16 v[148:151], a[24:27], v[120:123], v[148:151]
    ds_read_b128 a[24:27], v168 offset:50016
    v_mfma_f32_16x16x32_bf16 v[148:151], a[28:31], v[124:127], v[148:151]
    ds_read_b128 a[28:31], v168 offset:50032
    s_add_u32 s51, s60, 10200
    s_add_u32 m0, s42, 5200
    s_waitcnt lgkmcnt(6)
    v_mfma_f32_16x16x32_bf16 v[152:155], a[0:3], v[0:3], 0
    buffer_load_dwordx4 v170, s[8:11], s51 offen lds
    v_mfma_f32_16x16x32_bf16 v[152:155], a[4:7], v[4:7], v[152:155]
    s_waitcnt lgkmcnt(4)
    v_mfma_f32_16x16x32_bf16 v[152:155], a[8:11], v[8:11], v[152:155]
    v_mfma_f32_16x16x32_bf16 v[152:155], a[12:15], v[12:15], v[152:155]
    v_mfma_f32_16x16x32_bf16 v[156:159], a[0:3], v[64:67], 0
    ds_read_b128 a[0:3], v168 offset:50048
    v_mfma_f32_16x16x32_bf16 v[156:159], a[4:7], v[68:71], v[156:159]
    ds_read_b128 a[4:7], v168 offset:50064
    v_mfma_f32_16x16x32_bf16 v[156:159], a[8:11], v[72:75], v[156:159]
    ds_read_b128 a[8:11], v168 offset:50080
    v_mfma_f32_16x16x32_bf16 v[156:159], a[12:15], v[76:79], v[156:159]
    ds_read_b128 a[12:15], v168 offset:50096
    s_add_u32 s51, s60, 12240
    s_add_u32 m0, s42, 6240
    s_waitcnt lgkmcnt(6)
    v_mfma_f32_16x16x32_bf16 v[152:155], a[16:19], v[16:19], v[152:155]
    buffer_load_dwordx4 v170, s[8:11], s51 offen lds
    v_mfma_f32_16x16x32_bf16 v[152:155], a[20:23], v[20:23], v[152:155]
    s_waitcnt lgkmcnt(4)
    v_mfma_f32_16x16x32_bf16 v[152:155], a[24:27], v[24:27], v[152:155]
    v_mfma_f32_16x16x32_bf16 v[152:155], a[28:31], v[28:31], v[152:155]
    v_mfma_f32_16x16x32_bf16 v[156:159], a[16:19], v[80:83], v[156:159]
    ds_read_b128 a[16:19], v168 offset:50112
    v_mfma_f32_16x16x32_bf16 v[156:159], a[20:23], v[84:87], v[156:159]
    ds_read_b128 a[20:23], v168 offset:50128
    v_mfma_f32_16x16x32_bf16 v[156:159], a[24:27], v[88:91], v[156:159]
    ds_read_b128 a[24:27], v168 offset:50144
    v_mfma_f32_16x16x32_bf16 v[156:159], a[28:31], v[92:95], v[156:159]
    ds_read_b128 a[28:31], v168 offset:50160
    s_add_u32 s51, s60, 14280
    s_add_u32 m0, s42, 7280
    s_waitcnt lgkmcnt(6)
    v_mfma_f32_16x16x32_bf16 v[152:155], a[0:3], v[32:35], v[152:155]
    buffer_load_dwordx4 v170, s[8:11], s51 offen lds
    v_mfma_f32_16x16x32_bf16 v[152:155], a[4:7], v[36:39], v[152:155]
    s_waitcnt lgkmcnt(4)
    v_mfma_f32_16x16x32_bf16 v[152:155], a[8:11], v[40:43], v[152:155]
    v_mfma_f32_16x16x32_bf16 v[152:155], a[12:15], v[44:47], v[152:155]
    s_waitcnt vmcnt(8) lgkmcnt(0)
    s_barrier
    v_mfma_f32_16x16x32_bf16 v[156:159], a[0:3], v[96:99], v[156:159]
    ds_read_b128 a[0:3], v169 offset:0
    v_mfma_f32_16x16x32_bf16 v[156:159], a[4:7], v[100:103], v[156:159]
    ds_read_b128 a[4:7], v169 offset:16
    v_mfma_f32_16x16x32_bf16 v[156:159], a[8:11], v[104:107], v[156:159]
    ds_read_b128 a[8:11], v169 offset:32
    v_mfma_f32_16x16x32_bf16 v[156:159], a[12:15], v[108:111], v[156:159]
    ds_read_b128 a[12:15], v169 offset:48
    v_mfma_f32_16x16x32_bf16 v[152:155], a[16:19], v[48:51], v[152:155]
    v_mfma_f32_16x16x32_bf16 v[152:155], a[20:23], v[52:55], v[152:155]
    ds_write_b128 v172, a[48:51] offset:16640
    v_mfma_f32_16x16x32_bf16 v[152:155], a[24:27], v[56:59], v[152:155]
    v_mfma_f32_16x16x32_bf16 v[152:155], a[28:31], v[60:63], v[152:155]
    v_mfma_f32_16x16x32_bf16 v[156:159], a[16:19], v[112:115], v[156:159]
    ds_read_b128 a[16:19], v169 offset:64
    v_mfma_f32_16x16x32_bf16 v[156:159], a[20:23], v[116:119], v[156:159]
    ds_read_b128 a[20:23], v169 offset:80
    v_mfma_f32_16x16x32_bf16 v[156:159], a[24:27], v[120:123], v[156:159]
    ds_read_b128 a[24:27], v169 offset:96
    v_mfma_f32_16x16x32_bf16 v[156:159], a[28:31], v[124:127], v[156:159]
    ds_read_b128 a[28:31], v169 offset:112
    s_waitcnt lgkmcnt(7)
    v_mfma_f32_16x16x32_bf16 a[32:35], a[0:3], v[0:3], 0
    ds_write_b128 v172, a[52:55] offset:17664
    v_mfma_f32_16x16x32_bf16 a[32:35], a[4:7], v[4:7], a[32:35]
    s_waitcnt lgkmcnt(6)
    v_mfma_f32_16x16x32_bf16 a[32:35], a[8:11], v[8:11], a[32:35]
    v_mfma_f32_16x16x32_bf16 a[32:35], a[12:15], v[12:15], a[32:35]
    v_mfma_f32_16x16x32_bf16 a[36:39], a[0:3], v[64:67], 0
    ds_read_b128 a[0:3], v169 offset:128
    v_mfma_f32_16x16x32_bf16 a[36:39], a[4:7], v[68:71], a[36:39]
    ds_read_b128 a[4:7], v169 offset:144
    v_mfma_f32_16x16x32_bf16 a[36:39], a[8:11], v[72:75], a[36:39]
    ds_read_b128 a[8:11], v169 offset:160
    v_mfma_f32_16x16x32_bf16 a[36:39], a[12:15], v[76:79], a[36:39]
    ds_read_b128 a[12:15], v169 offset:176
    s_waitcnt lgkmcnt(7)
    v_mfma_f32_16x16x32_bf16 a[32:35], a[16:19], v[16:19], a[32:35]
    ds_write_b128 v172, a[56:59] offset:18688
    v_mfma_f32_16x16x32_bf16 a[32:35], a[20:23], v[20:23], a[32:35]
    s_waitcnt lgkmcnt(6)
    v_mfma_f32_16x16x32_bf16 a[32:35], a[24:27], v[24:27], a[32:35]
    v_mfma_f32_16x16x32_bf16 a[32:35], a[28:31], v[28:31], a[32:35]
    v_mfma_f32_16x16x32_bf16 a[36:39], a[16:19], v[80:83], a[36:39]
    ds_read_b128 a[16:19], v169 offset:192
    v_mfma_f32_16x16x32_bf16 a[36:39], a[20:23], v[84:87], a[36:39]
    ds_read_b128 a[20:23], v169 offset:208
    v_mfma_f32_16x16x32_bf16 a[36:39], a[24:27], v[88:91], a[36:39]
    ds_read_b128 a[24:27], v169 offset:224
    v_mfma_f32_16x16x32_bf16 a[36:39], a[28:31], v[92:95], a[36:39]
    ds_read_b128 a[28:31], v169 offset:240
    s_waitcnt lgkmcnt(7)
    v_mfma_f32_16x16x32_bf16 a[32:35], a[0:3], v[32:35], a[32:35]
    ds_write_b128 v172, a[60:63] offset:19712
    v_mfma_f32_16x16x32_bf16 a[32:35], a[4:7], v[36:39], a[32:35]
    s_waitcnt lgkmcnt(6)
    v_mfma_f32_16x16x32_bf16 a[32:35], a[8:11], v[40:43], a[32:35]
    s_add_u32 s54, s39, 0
    s_sub_u32 s51, s54, 7
    s_min_u32 s54, s54, s51
    s_mul_i32 s54, s54, 65280
    s_add_u32 s54, s54, s43
    s_add_u32 m0, s42, 33280
    v_mfma_f32_16x16x32_bf16 a[32:35], a[12:15], v[44:47], a[32:35]
    buffer_load_dwordx4 v171, s[8:11], s54 offen lds
    v_mfma_f32_16x16x32_bf16 a[36:39], a[0:3], v[96:99], a[36:39]
    ds_read_b128 a[0:3], v169 offset:16640
    v_mfma_f32_16x16x32_bf16 a[36:39], a[4:7], v[100:103], a[36:39]
    ds_read_b128 a[4:7], v169 offset:16656
    v_mfma_f32_16x16x32_bf16 a[36:39], a[8:11], v[104:107], a[36:39]
    ds_read_b128 a[8:11], v169 offset:16672
    v_mfma_f32_16x16x32_bf16 a[36:39], a[12:15], v[108:111], a[36:39]
    ds_read_b128 a[12:15], v169 offset:16688
    s_add_u32 s51, s54, 2040
    s_add_u32 m0, s42, 34320
    s_waitcnt lgkmcnt(7)
    v_mfma_f32_16x16x32_bf16 a[32:35], a[16:19], v[48:51], a[32:35]
    buffer_load_dwordx4 v171, s[8:11], s51 offen lds
    v_mfma_f32_16x16x32_bf16 a[32:35], a[20:23], v[52:55], a[32:35]
    s_add_u32 s51, s54, 4080
    s_add_u32 m0, s42, 35360
    s_waitcnt lgkmcnt(5)
    v_mfma_f32_16x16x32_bf16 a[32:35], a[24:27], v[56:59], a[32:35]
    buffer_load_dwordx4 v171, s[8:11], s51 offen lds
    v_mfma_f32_16x16x32_bf16 a[32:35], a[28:31], v[60:63], a[32:35]
    v_mfma_f32_16x16x32_bf16 a[36:39], a[16:19], v[112:115], a[36:39]
    ds_read_b128 a[16:19], v169 offset:16704
    v_mfma_f32_16x16x32_bf16 a[36:39], a[20:23], v[116:119], a[36:39]
    ds_read_b128 a[20:23], v169 offset:16720
    v_mfma_f32_16x16x32_bf16 a[36:39], a[24:27], v[120:123], a[36:39]
    ds_read_b128 a[24:27], v169 offset:16736
    v_mfma_f32_16x16x32_bf16 a[36:39], a[28:31], v[124:127], a[36:39]
    ds_read_b128 a[28:31], v169 offset:16752
    s_add_u32 s51, s54, 6120
    s_add_u32 m0, s42, 36400
    s_waitcnt lgkmcnt(6)
    v_mfma_f32_16x16x32_bf16 a[40:43], a[0:3], v[0:3], 0
    buffer_load_dwordx4 v171, s[8:11], s51 offen lds
    v_mfma_f32_16x16x32_bf16 a[40:43], a[4:7], v[4:7], a[40:43]
    s_add_u32 s51, s54, 8160
    s_add_u32 m0, s42, 37440
    s_waitcnt lgkmcnt(4)
    v_mfma_f32_16x16x32_bf16 a[40:43], a[8:11], v[8:11], a[40:43]
    buffer_load_dwordx4 v171, s[8:11], s51 offen lds
    v_mfma_f32_16x16x32_bf16 a[40:43], a[12:15], v[12:15], a[40:43]
    v_mfma_f32_16x16x32_bf16 a[44:47], a[0:3], v[64:67], 0
    ds_read_b128 a[0:3], v169 offset:16768
    v_mfma_f32_16x16x32_bf16 a[44:47], a[4:7], v[68:71], a[44:47]
    ds_read_b128 a[4:7], v169 offset:16784
    v_mfma_f32_16x16x32_bf16 a[44:47], a[8:11], v[72:75], a[44:47]
    ds_read_b128 a[8:11], v169 offset:16800
    v_mfma_f32_16x16x32_bf16 a[44:47], a[12:15], v[76:79], a[44:47]
    ds_read_b128 a[12:15], v169 offset:16816
    s_add_u32 s51, s54, 10200
    s_add_u32 m0, s42, 38480
    s_waitcnt lgkmcnt(6)
    v_mfma_f32_16x16x32_bf16 a[40:43], a[16:19], v[16:19], a[40:43]
    buffer_load_dwordx4 v171, s[8:11], s51 offen lds
    v_mfma_f32_16x16x32_bf16 a[40:43], a[20:23], v[20:23], a[40:43]
    s_add_u32 s51, s54, 12240
    s_add_u32 m0, s42, 39520
    s_waitcnt lgkmcnt(4)
    v_mfma_f32_16x16x32_bf16 a[40:43], a[24:27], v[24:27], a[40:43]
    buffer_load_dwordx4 v171, s[8:11], s51 offen lds
    v_mfma_f32_16x16x32_bf16 a[40:43], a[28:31], v[28:31], a[40:43]
    v_mfma_f32_16x16x32_bf16 a[44:47], a[16:19], v[80:83], a[44:47]
    ds_read_b128 a[16:19], v169 offset:16832
    v_mfma_f32_16x16x32_bf16 a[44:47], a[20:23], v[84:87], a[44:47]
    ds_read_b128 a[20:23], v169 offset:16848
    v_mfma_f32_16x16x32_bf16 a[44:47], a[24:27], v[88:91], a[44:47]
    ds_read_b128 a[24:27], v169 offset:16864
    v_mfma_f32_16x16x32_bf16 a[44:47], a[28:31], v[92:95], a[44:47]
    ds_read_b128 a[28:31], v169 offset:16880
    s_add_u32 s51, s54, 14280
    s_add_u32 m0, s42, 40560
    s_waitcnt lgkmcnt(6)
    v_mfma_f32_16x16x32_bf16 a[40:43], a[0:3], v[32:35], a[40:43]
    buffer_load_dwordx4 v171, s[8:11], s51 offen lds
    v_mfma_f32_16x16x32_bf16 a[40:43], a[4:7], v[36:39], a[40:43]
    s_waitcnt lgkmcnt(4)
    v_mfma_f32_16x16x32_bf16 a[40:43], a[8:11], v[40:43], a[40:43]
    v_mfma_f32_16x16x32_bf16 a[40:43], a[12:15], v[44:47], a[40:43]
    s_waitcnt vmcnt(8) lgkmcnt(0)
    s_barrier
    v_mfma_f32_16x16x32_bf16 a[44:47], a[0:3], v[96:99], a[44:47]
    ds_read_b128 a[0:3], v168 offset:0
    v_mfma_f32_16x16x32_bf16 a[44:47], a[4:7], v[100:103], a[44:47]
    ds_read_b128 a[4:7], v168 offset:16
    v_mfma_f32_16x16x32_bf16 a[44:47], a[8:11], v[104:107], a[44:47]
    ds_read_b128 a[8:11], v168 offset:32
    v_mfma_f32_16x16x32_bf16 a[44:47], a[12:15], v[108:111], a[44:47]
    ds_read_b128 a[12:15], v168 offset:48
    s_add_u32 s55, s39, 1
    s_sub_u32 s51, s55, 7
    s_min_u32 s55, s55, s51
    s_mul_i32 s55, s55, 65280
    s_add_u32 s55, s55, s43
    s_add_u32 m0, s42, 66560
    v_mfma_f32_16x16x32_bf16 a[40:43], a[16:19], v[48:51], a[40:43]
    buffer_load_dwordx4 v171, s[8:11], s55 offen lds
    v_mfma_f32_16x16x32_bf16 a[40:43], a[20:23], v[52:55], a[40:43]
    v_mfma_f32_16x16x32_bf16 a[40:43], a[24:27], v[56:59], a[40:43]
    v_mfma_f32_16x16x32_bf16 a[40:43], a[28:31], v[60:63], a[40:43]
    v_mfma_f32_16x16x32_bf16 a[44:47], a[16:19], v[112:115], a[44:47]
    ds_read_b128 a[16:19], v168 offset:64
    v_mfma_f32_16x16x32_bf16 a[44:47], a[20:23], v[116:119], a[44:47]
    ds_read_b128 a[20:23], v168 offset:80
    v_mfma_f32_16x16x32_bf16 a[44:47], a[24:27], v[120:123], a[44:47]
    ds_read_b128 a[24:27], v168 offset:96
    v_mfma_f32_16x16x32_bf16 a[44:47], a[28:31], v[124:127], a[44:47]
    ds_read_b128 a[28:31], v168 offset:112
    s_add_u32 s51, s55, 2040
    s_add_u32 m0, s42, 67600
    s_waitcnt lgkmcnt(6)
    v_mfma_f32_16x16x32_bf16 a[48:51], a[0:3], v[0:3], 0
    buffer_load_dwordx4 v171, s[8:11], s51 offen lds
    v_mfma_f32_16x16x32_bf16 a[48:51], a[4:7], v[4:7], a[48:51]
    s_waitcnt lgkmcnt(4)
    v_mfma_f32_16x16x32_bf16 a[48:51], a[8:11], v[8:11], a[48:51]
    v_mfma_f32_16x16x32_bf16 a[48:51], a[12:15], v[12:15], a[48:51]
    v_mfma_f32_16x16x32_bf16 a[52:55], a[0:3], v[64:67], 0
    ds_read_b128 a[0:3], v168 offset:128
    v_mfma_f32_16x16x32_bf16 a[52:55], a[4:7], v[68:71], a[52:55]
    ds_read_b128 a[4:7], v168 offset:144
    v_mfma_f32_16x16x32_bf16 a[52:55], a[8:11], v[72:75], a[52:55]
    ds_read_b128 a[8:11], v168 offset:160
    v_mfma_f32_16x16x32_bf16 a[52:55], a[12:15], v[76:79], a[52:55]
    ds_read_b128 a[12:15], v168 offset:176
    s_add_u32 s51, s55, 4080
    s_add_u32 m0, s42, 68640
    s_waitcnt lgkmcnt(6)
    v_mfma_f32_16x16x32_bf16 a[48:51], a[16:19], v[16:19], a[48:51]
    buffer_load_dwordx4 v171, s[8:11], s51 offen lds
    v_mfma_f32_16x16x32_bf16 a[48:51], a[20:23], v[20:23], a[48:51]
    s_waitcnt lgkmcnt(4)
    v_mfma_f32_16x16x32_bf16 a[48:51], a[24:27], v[24:27], a[48:51]
    v_mfma_f32_16x16x32_bf16 a[48:51], a[28:31], v[28:31], a[48:51]
    v_mfma_f32_16x16x32_bf16 a[52:55], a[16:19], v[80:83], a[52:55]
    ds_read_b128 a[16:19], v168 offset:192
    v_mfma_f32_16x16x32_bf16 a[52:55], a[20:23], v[84:87], a[52:55]
    ds_read_b128 a[20:23], v168 offset:208
    v_mfma_f32_16x16x32_bf16 a[52:55], a[24:27], v[88:91], a[52:55]
    ds_read_b128 a[24:27], v168 offset:224
    v_mfma_f32_16x16x32_bf16 a[52:55], a[28:31], v[92:95], a[52:55]
    ds_read_b128 a[28:31], v168 offset:240
    s_add_u32 s51, s55, 6120
    s_add_u32 m0, s42, 69680
    s_waitcnt lgkmcnt(6)
    v_mfma_f32_16x16x32_bf16 a[48:51], a[0:3], v[32:35], a[48:51]
    buffer_load_dwordx4 v171, s[8:11], s51 offen lds
    v_mfma_f32_16x16x32_bf16 a[48:51], a[4:7], v[36:39], a[48:51]
    s_waitcnt lgkmcnt(4)
    v_mfma_f32_16x16x32_bf16 a[48:51], a[8:11], v[40:43], a[48:51]
    v_mfma_f32_16x16x32_bf16 a[48:51], a[12:15], v[44:47], a[48:51]
    v_mfma_f32_16x16x32_bf16 a[52:55], a[0:3], v[96:99], a[52:55]
    ds_read_b128 a[0:3], v168 offset:16640
    v_mfma_f32_16x16x32_bf16 a[52:55], a[4:7], v[100:103], a[52:55]
    ds_read_b128 a[4:7], v168 offset:16656
    v_mfma_f32_16x16x32_bf16 a[52:55], a[8:11], v[104:107], a[52:55]
    ds_read_b128 a[8:11], v168 offset:16672
    v_mfma_f32_16x16x32_bf16 a[52:55], a[12:15], v[108:111], a[52:55]
    ds_read_b128 a[12:15], v168 offset:16688
    s_add_u32 s51, s55, 8160
    s_add_u32 m0, s42, 70720
    s_waitcnt lgkmcnt(6)
    v_mfma_f32_16x16x32_bf16 a[48:51], a[16:19], v[48:51], a[48:51]
    buffer_load_dwordx4 v171, s[8:11], s51 offen lds
    v_mfma_f32_16x16x32_bf16 a[48:51], a[20:23], v[52:55], a[48:51]
    s_waitcnt lgkmcnt(4)
    v_mfma_f32_16x16x32_bf16 a[48:51], a[24:27], v[56:59], a[48:51]
    v_mfma_f32_16x16x32_bf16 a[48:51], a[28:31], v[60:63], a[48:51]
    v_mfma_f32_16x16x32_bf16 a[52:55], a[16:19], v[112:115], a[52:55]
    ds_read_b128 a[16:19], v168 offset:16704
    v_mfma_f32_16x16x32_bf16 a[52:55], a[20:23], v[116:119], a[52:55]
    ds_read_b128 a[20:23], v168 offset:16720
    v_mfma_f32_16x16x32_bf16 a[52:55], a[24:27], v[120:123], a[52:55]
    ds_read_b128 a[24:27], v168 offset:16736
    v_mfma_f32_16x16x32_bf16 a[52:55], a[28:31], v[124:127], a[52:55]
    ds_read_b128 a[28:31], v168 offset:16752
    s_add_u32 s51, s55, 10200
    s_add_u32 m0, s42, 71760
    s_waitcnt lgkmcnt(6)
    v_mfma_f32_16x16x32_bf16 a[56:59], a[0:3], v[0:3], 0
    buffer_load_dwordx4 v171, s[8:11], s51 offen lds
    v_mfma_f32_16x16x32_bf16 a[56:59], a[4:7], v[4:7], a[56:59]
    s_waitcnt lgkmcnt(4)
    v_mfma_f32_16x16x32_bf16 a[56:59], a[8:11], v[8:11], a[56:59]
    v_mfma_f32_16x16x32_bf16 a[56:59], a[12:15], v[12:15], a[56:59]
    v_mfma_f32_16x16x32_bf16 a[60:63], a[0:3], v[64:67], 0
    ds_read_b128 a[0:3], v168 offset:16768
    v_mfma_f32_16x16x32_bf16 a[60:63], a[4:7], v[68:71], a[60:63]
    ds_read_b128 a[4:7], v168 offset:16784
    v_mfma_f32_16x16x32_bf16 a[60:63], a[8:11], v[72:75], a[60:63]
    ds_read_b128 a[8:11], v168 offset:16800
    v_mfma_f32_16x16x32_bf16 a[60:63], a[12:15], v[76:79], a[60:63]
    ds_read_b128 a[12:15], v168 offset:16816
    s_add_u32 s51, s55, 12240
    s_add_u32 m0, s42, 72800
    s_waitcnt lgkmcnt(6)
    v_mfma_f32_16x16x32_bf16 a[56:59], a[16:19], v[16:19], a[56:59]
    buffer_load_dwordx4 v171, s[8:11], s51 offen lds
    v_mfma_f32_16x16x32_bf16 a[56:59], a[20:23], v[20:23], a[56:59]
    s_waitcnt lgkmcnt(4)
    v_mfma_f32_16x16x32_bf16 a[56:59], a[24:27], v[24:27], a[56:59]
    v_mfma_f32_16x16x32_bf16 a[56:59], a[28:31], v[28:31], a[56:59]
    v_mfma_f32_16x16x32_bf16 a[60:63], a[16:19], v[80:83], a[60:63]
    ds_read_b128 a[16:19], v168 offset:16832
    v_mfma_f32_16x16x32_bf16 a[60:63], a[20:23], v[84:87], a[60:63]
    ds_read_b128 a[20:23], v168 offset:16848
    v_mfma_f32_16x16x32_bf16 a[60:63], a[24:27], v[88:91], a[60:63]
    ds_read_b128 a[24:27], v168 offset:16864
    v_mfma_f32_16x16x32_bf16 a[60:63], a[28:31], v[92:95], a[60:63]
    ds_read_b128 a[28:31], v168 offset:16880
    s_add_u32 s51, s55, 14280
    s_add_u32 m0, s42, 73840
    s_nop 0
    buffer_load_dwordx4 v171, s[8:11], s51 offen lds
    s_cmp_eq_u32 s41, 0
    s_cbranch_scc1 L_s6short
    s_waitcnt lgkmcnt(6)
    v_mfma_f32_16x16x32_bf16 a[56:59], a[0:3], v[32:35], a[56:59]
    v_mfma_f32_16x16x32_bf16 a[56:59], a[4:7], v[36:39], a[56:59]
L_pad2:
    s_cbranch_execz L_pad6
    s_waitcnt lgkmcnt(4)
    v_mfma_f32_16x16x32_bf16 a[56:59], a[8:11], v[40:43], a[56:59]
    v_mfma_f32_16x16x32_bf16 a[56:59], a[12:15], v[44:47], a[56:59]
    v_mfma_f32_16x16x32_bf16 a[60:63], a[0:3], v[96:99], a[60:63]
    ds_read_b128 a[0:3], v173 offset:0
    v_mfma_f32_16x16x32_bf16 a[60:63], a[4:7], v[100:103], a[60:63]
    ds_read_b128 a[4:7], v173 offset:16
    v_mfma_f32_16x16x32_bf16 a[60:63], a[8:11], v[104:107], a[60:63]
    ds_read_b128 a[8:11], v173 offset:32
    v_mfma_f32_16x16x32_bf16 a[60:63], a[12:15], v[108:111], a[60:63]
    ds_read_b128 a[12:15], v173 offset:48
    s_waitcnt lgkmcnt(6)
    v_mfma_f32_16x16x32_bf16 a[56:59], a[16:19], v[48:51], a[56:59]
    v_mfma_f32_16x16x32_bf16 a[56:59], a[20:23], v[52:55], a[56:59]
    s_waitcnt lgkmcnt(4)
    v_mfma_f32_16x16x32_bf16 a[56:59], a[24:27], v[56:59], a[56:59]
    v_mfma_f32_16x16x32_bf16 a[56:59], a[28:31], v[60:63], a[56:59]
    v_mfma_f32_16x16x32_bf16 a[60:63], a[16:19], v[112:115], a[60:63]
    ds_read_b128 a[16:19], v173 offset:64
    v_mfma_f32_16x16x32_bf16 a[60:63], a[20:23], v[116:119], a[60:63]
    ds_read_b128 a[20:23], v173 offset:80
    v_mfma_f32_16x16x32_bf16 a[60:63], a[24:27], v[120:123], a[60:63]
    ds_read_b128 a[24:27], v173 offset:96
    v_mfma_f32_16x16x32_bf16 a[60:63], a[28:31], v[124:127], a[60:63]
    ds_read_b128 a[28:31], v173 offset:112
    s_waitcnt lgkmcnt(6)
    v_mfma_f32_16x16x32_bf16 v[160:163], a[0:3], v[0:3], 0
    v_mfma_f32_16x16x32_bf16 v[160:163], a[4:7], v[4:7], v[160:163]
    s_waitcnt lgkmcnt(4)
    v_mfma_f32_16x16x32_bf16 v[160:163], a[8:11], v[8:11], v[160:163]
    v_mfma_f32_16x16x32_bf16 v[160:163], a[12:15], v[12:15], v[160:163]
    v_mfma_f32_16x16x32_bf16 v[164:167], a[0:3], v[64:67], 0
    ds_read_b128 a[0:3], v173 offset:128
    v_mfma_f32_16x16x32_bf16 v[164:167], a[4:7], v[68:71], v[164:167]
    ds_read_b128 a[4:7], v173 offset:144
    v_mfma_f32_16x16x32_bf16 v[164:167], a[8:11], v[72:75], v[164:167]
    ds_read_b128 a[8:11], v173 offset:160
    v_mfma_f32_16x16x32_bf16 v[164:167], a[12:15], v[76:79], v[164:167]
    ds_read_b128 a[12:15], v173 offset:176
    s_waitcnt lgkmcnt(6)
    v_mfma_f32_16x16x32_bf16 v[160:163], a[16:19], v[16:19], v[160:163]
    v_mfma_f32_16x16x32_bf16 v[160:163], a[20:23], v[20:23], v[160:163]
    s_waitcnt lgkmcnt(4)
    v_mfma_f32_16x16x32_bf16 v[160:163], a[24:27], v[24:27], v[160:163]
    v_mfma_f32_16x16x32_bf16 v[160:163], a[28:31], v[28:31], v[160:163]
    v_mfma_f32_16x16x32_bf16 v[164:167], a[16:19], v[80:83], v[164:167]
    ds_read_b128 a[16:19], v173 offset:192
    v_mfma_f32_16x16x32_bf16 v[164:167], a[20:23], v[84:87], v[164:167]
    ds_read_b128 a[20:23], v173 offset:208
    v_mfma_f32_16x16x32_bf16 v[164:167], a[24:27], v[88:91], v[164:167]
    ds_read_b128 a[24:27], v173 offset:224
    v_mfma_f32_16x16x32_bf16 v[164:167], a[28:31], v[92:95], v[164:167]
    ds_read_b128 a[28:31], v173 offset:240
    s_waitcnt lgkmcnt(6)
    v_mfma_f32_16x16x32_bf16 v[160:163], a[0:3], v[32:35], v[160:163]
    v_mfma_f32_16x16x32_bf16 v[160:163], a[4:7], v[36:39], v[160:163]
    s_waitcnt lgkmcnt(4)
    v_mfma_f32_16x16x32_bf16 v[160:163], a[8:11], v[40:43], v[160:163]
    v_mfma_f32_16x16x32_bf16 v[160:163], a[12:15], v[44:47], v[160:163]
    s_waitcnt vmcnt(8) lgkmcnt(0)
    s_barrier
    s_setprio 3
    v_mfma_f32_16x16x32_bf16 v[164:167], a[0:3], v[96:99], v[164:167]
    v_mfma_f32_16x16x32_bf16 v[164:167], a[4:7], v[100:103], v[164:167]
    v_mfma_f32_16x16x32_bf16 v[164:167], a[8:11], v[104:107], v[164:167]
    v_mfma_f32_16x16x32_bf16 v[164:167], a[12:15], v[108:111], v[164:167]
    v_mfma_f32_16x16x32_bf16 v[160:163], a[16:19], v[48:51], v[160:163]
    v_mfma_f32_16x16x32_bf16 v[160:163], a[20:23], v[52:55], v[160:163]
    v_mfma_f32_16x16x32_bf16 v[160:163], a[24:27], v[56:59], v[160:163]
    v_mfma_f32_16x16x32_bf16 v[160:163], a[28:31], v[60:63], v[160:163]
    v_mfma_f32_16x16x32_bf16 v[164:167], a[16:19], v[112:115], v[164:167]
    v_mfma_f32_16x16x32_bf16 v[164:167], a[20:23], v[116:119], v[164:167]
    v_mfma_f32_16x16x32_bf16 v[164:167], a[24:27], v[120:123], v[164:167]
    v_mfma_f32_16x16x32_bf16 v[164:167], a[28:31], v[124:127], v[164:167]
    s_branch L_s6join
L_s6short:
    s_waitcnt lgkmcnt(6)
    v_mfma_f32_16x16x32_bf16 a[56:59], a[0:3], v[32:35], a[56:59]
    v_mfma_f32_16x16x32_bf16 a[56:59], a[4:7], v[36:39], a[56:59]
    s_waitcnt lgkmcnt(4)
    v_mfma_f32_16x16x32_bf16 a[56:59], a[8:11], v[40:43], a[56:59]
    v_mfma_f32_16x16x32_bf16 a[56:59], a[12:15], v[44:47], a[56:59]
    s_waitcnt vmcnt(8) lgkmcnt(0)
    s_barrier
    s_setprio 3
    v_mfma_f32_16x16x32_bf16 a[60:63], a[0:3], v[96:99], a[60:63]
    v_mfma_f32_16x16x32_bf16 a[60:63], a[4:7], v[100:103], a[60:63]
    v_mfma_f32_16x16x32_bf16 a[60:63], a[8:11], v[104:107], a[60:63]
    v_mfma_f32_16x16x32_bf16 a[60:63], a[12:15], v[108:111], a[60:63]
    v_mfma_f32_16x16x32_bf16 a[56:59], a[16:19], v[48:51], a[56:59]
    v_mfma_f32_16x16x32_bf16 a[56:59], a[20:23], v[52:55], a[56:59]
    v_mfma_f32_16x16x32_bf16 a[56:59], a[24:27], v[56:59], a[56:59]
    v_mfma_f32_16x16x32_bf16 a[56:59], a[28:31], v[60:63], a[56:59]
    v_mfma_f32_16x16x32_bf16 a[60:63], a[16:19], v[112:115], a[60:63]
    v_mfma_f32_16x16x32_bf16 a[60:63], a[20:23], v[116:119], a[60:63]
    v_mfma_f32_16x16x32_bf16 a[60:63], a[24:27], v[120:123], a[60:63]
    v_mfma_f32_16x16x32_bf16 a[60:63], a[28:31], v[124:127], a[60:63]
    s_branch L_s6join
.p2align 6
L_Y:
    v_and_b32 v12, 15, v4
    v_mul_u32_u24 v170, 240, v10
    v_lshl_add_u32 v170, v12, 4, v170
    v_cmp_eq_u32 vcc, 15, v12
    v_lshlrev_b32 v13, 4, v10
    v_add_u32 v171, 960, v170
    v_add_u32 v14, 1920, v13
    v_add_u32 v13, 1984, v13
    v_min_u32 v13, 2024, v13
    v_cndmask_b32 v170, v170, v14, vcc
    v_cndmask_b32 v171, v171, v13, vcc
    s_cmp_eq_u32 s38, 7
    s_cselect_b32 s41, 1, 0
    s_cmp_eq_u32 s38, 8
    s_cselect_b32 s41, 1, s41
    s_mul_i32 s45, s38, 14
    s_cmp_gt_u32 s38, 7
    s_addc_u32 s45, s45, 0
    s_cmp_gt_u32 s38, 8
    s_addc_u32 s38, s45, 0
    s_mov_b32 s69, s39
    s_mov_b32 s70, 0x4152630
    s_mov_b32 s71, 0x415263
    s_lshl_b32 s39, s39, 2
    s_lshr_b64 s[70:71], s[70:71], s39
    s_and_b32 s39, s70, 15
    s_mul_i32 s43, s38, 32640
    s_mul_i32 s45, s40, 16320
    s_add_u32 s43, s43, s45
    s_mul_i32 s42, s40, 8320
    s_add_u32 s54, s39, 0
    s_sub_u32 s51, s54, 7
    s_min_u32 s54, s54, s51
    s_mul_i32 s54, s54, 65280
    s_add_u32 s54, s54, s43
    s_add_u32 s55, s39, 1
    s_sub_u32 s51, s55, 7
    s_min_u32 s55, s55, s51
    s_mul_i32 s55, s55, 65280
    s_add_u32 s55, s55, s43
    v_add_u32 v12, 1, v11
    v_lshrrev_b32 v12, 1, v12
    v_add_u32 v12, v12, v6
    v_mul_u32_u24 v12, 14336, v12
    v_add_u32 v45, v45, v12
    v_lshlrev_b32 v47, 3, v7
    v_lshl_add_u32 v47, v10, 7, v47
    v_add_u32 v47, s49, v47
    v_mov_b32 v156, 0x0007000e
    v_mov_b32 v157, 0x00380070
    v_mov_b32 v158, 0x01c00380
    s_mov_b32 s34, 0x48000000
    s_mov_b32 s35, 0x3fffffff
    s_mov_b32 s52, 0xffff0000
    v_lshlrev_b32 v12, 3, v10
    s_mov_b32 s45, 0x12180006
    v_lshrrev_b32 v161, v12, s45
    v_and_b32 v161, 0xff, v161
    v_sub_u32 v162, 30, v161
    v_and_b32 v12, 15, v4
    v_mul_u32_u24 v168, 1040, v12
    v_lshl_add_u32 v168, v10, 8, v168
    v_add_u32 v169, 66560, v168
    s_lshl_b32 s45, s40, 12
    s_add_u32 s45, s45, 99840
    v_lshl_add_u32 v172, v4, 4, s45
    s_mov_b32 s32, 0
    s_mov_b32 s33, 0xffff0000
    v_lshrrev_b32 v12, 2, v4
    v_mul_u32_u24 v173, 7168, v12
    v_and_b32 v12, 3, v4
    v_lshl_add_u32 v173, v12, 4, v173
    v_add_u32 v173, s46, v173
    v_add_u32 v174, 114688, v173
    s_mov_b32 s26, 14680064
    s_mov_b32 s27, 0x20000
    s_mul_i32 s44, s38, 114688
    s_add_u32 s65, s44, 1605632
    s_mul_i32 s63, s39, 229376
    s_add_u32 s63, s63, s44
    s_mov_b32 s62, 14680064
    s_add_u32 s56, s39, 2
    s_sub_u32 s51, s56, 7
    s_min_u32 s56, s56, s51
    s_mul_i32 s56, s56, 65280
    s_add_u32 s56, s56, s43
    s_add_u32 s57, s39, 3
    s_sub_u32 s51, s57, 7
    s_min_u32 s57, s57, s51
    s_mul_i32 s57, s57, 65280
    s_add_u32 s57, s57, s43
    s_add_u32 s58, s39, 4
    s_sub_u32 s51, s58, 7
    s_min_u32 s58, s58, s51
    s_mul_i32 s58, s58, 65280
    s_add_u32 s58, s58, s43
    s_add_u32 s59, s39, 5
    s_sub_u32 s51, s59, 7
    s_min_u32 s59, s59, s51
    s_mul_i32 s59, s59, 65280
    s_add_u32 s59, s59, s43
    s_add_u32 s60, s39, 6
    s_sub_u32 s51, s60, 7
    s_min_u32 s60, s60, s51
    s_mul_i32 s60, s60, 65280
    s_add_u32 s60, s60, s43
    s_mul_i32 s61, s40, 8160
    s_sub_u32 s61, s43, s61
    s_add_u32 s61, s61, 456960
    v_cmp_lt_u32 vcc, 16, v4
    v_mov_b32 v13, 26384
    v_mov_b32 v14, 0
    v_lshlrev_b32 v15, 7, v4
    v_cndmask_b32 v13, v14, v13, vcc
    v_add_u32 v15, v15, v13
    s_mul_i32 s69, s69, 2040
    s_add_u32 s69, s69, s61
    s_waitcnt lgkmcnt(0)
    s_cmp_eq_u32 s41, s40
    s_cbranch_scc1 L_nxt
    s_cmp_lg_u32 s40, 0
    s_cbranch_scc1 L_nxt
    s_mov_b32 exec_hi, 3
    buffer_load_dword v16, v15, s[8:11], s69 offen
    s_mov_b32 exec_hi, -1
L_nxt:
    s_add_u32 m0, s42, 99840
    s_add_u32 s51, s54, 0
    buffer_load_dwordx4 v170, s[8:11], s54 offen lds
    s_add_u32 m0, s42, 100880
    s_add_u32 s51, s54, 2040
    buffer_load_dwordx4 v170, s[8:11], s51 offen lds
    s_add_u32 m0, s42, 101920
    s_add_u32 s51, s54, 4080
    buffer_load_dwordx4 v170, s[8:11], s51 offen lds
    s_add_u32 m0, s42, 102960
    s_add_u32 s51, s54, 6120
    buffer_load_dwordx4 v170, s[8:11], s51 offen lds
    s_add_u32 m0, s42, 104000
    s_add_u32 s51, s54, 8160
    buffer_load_dwordx4 v170, s[8:11], s51 offen lds
    s_add_u32 m0, s42, 105040
    s_add_u32 s51, s54, 10200
    buffer_load_dwordx4 v170, s[8:11], s51 offen lds
    s_add_u32 m0, s42, 106080
    s_add_u32 s51, s54, 12240
    buffer_load_dwordx4 v170, s[8:11], s51 offen lds
    s_add_u32 m0, s42, 107120
    s_add_u32 s51, s54, 14280
    buffer_load_dwordx4 v170, s[8:11], s51 offen lds
    s_add_u32 m0, s42, 33280
    s_add_u32 s51, s55, 0
    buffer_load_dwordx4 v170, s[8:11], s55 offen lds
    s_mov_b64 exec, 0
    s_cmp_eq_u32 s40, 0
    s_cbranch_scc1 L_pad0
    s_cmp_eq_u32 s40, 1
    s_cbranch_scc1 L_pad1
    s_cmp_eq_u32 s40, 2
    s_cbranch_scc1 L_pad2
    s_branch L_pad3
L_ret:
    s_mov_b64 exec, -1
    s_add_u32 m0, s42, 34320
    s_add_u32 s51, s55, 2040
    buffer_load_dwordx4 v170, s[8:11], s51 offen lds
    s_add_u32 m0, s42, 35360
    s_add_u32 s51, s55, 4080
    buffer_load_dwordx4 v170, s[8:11], s51 offen lds
    s_add_u32 m0, s42, 36400
    s_add_u32 s51, s55, 6120
    buffer_load_dwordx4 v170, s[8:11], s51 offen lds
    s_add_u32 m0, s42, 37440
    s_add_u32 s51, s55, 8160
    buffer_load_dwordx4 v170, s[8:11], s51 offen lds
    s_add_u32 m0, s42, 38480
    s_add_u32 s51, s55, 10200
    buffer_load_dwordx4 v170, s[8:11], s51 offen lds
    s_waitcnt vmcnt(6)
    s_barrier
    s_add_u32 m0, s42, 39520
    s_add_u32 s51, s55, 12240
    buffer_load_dwordx4 v170, s[8:11], s51 offen lds
    s_add_u32 m0, s42, 40560
    s_add_u32 s51, s55, 14280
    buffer_load_dwordx4 v170, s[8:11], s51 offen lds
    s_add_u32 m0, s42, 66560
    s_add_u32 s51, s56, 0
    buffer_load_dwordx4 v170, s[8:11], s56 offen lds
    s_add_u32 m0, s42, 67600
    s_add_u32 s51, s56, 2040
    buffer_load_dwordx4 v170, s[8:11], s51 offen lds
    s_add_u32 m0, s42, 68640
    s_add_u32 s51, s56, 4080
    buffer_load_dwordx4 v170, s[8:11], s51 offen lds
    s_add_u32 m0, s42, 69680
    s_add_u32 s51, s56, 6120
    buffer_load_dwordx4 v170, s[8:11], s51 offen lds
    s_add_u32 m0, s42, 70720
    s_add_u32 s51, s56, 8160
    buffer_load_dwordx4 v170, s[8:11], s51 offen lds
    s_add_u32 m0, s42, 71760
    s_add_u32 s51, s56, 10200
    buffer_load_dwordx4 v170, s[8:11], s51 offen lds
    s_waitcnt vmcnt(6)
    s_barrier
    s_add_u32 m0, s42, 72800
    s_add_u32 s51, s56, 12240
    buffer_load_dwordx4 v170, s[8:11], s51 offen lds
    s_add_u32 m0, s42, 73840
    s_add_u32 s51, s56, 14280
    buffer_load_dwordx4 v170, s[8:11], s51 offen lds
    s_add_u32 m0, s49, 0
    s_mov_b32 s47, 688128
    buffer_load_dwordx4 v44, s[12:15], s47 offen lds
    s_mov_b32 s48, 57344
    buffer_load_dword v56, v46, s[16:19], s48 offen
    buffer_load_dword v57, v46, s[20:23], s48 offen
    s_add_u32 m0, s49, 1024
    s_mov_b32 s47, 716800
    buffer_load_dwordx4 v44, s[12:15], s47 offen lds
    s_add_u32 m0, s49, 2048
    s_mov_b32 s47, 745472
    buffer_load_dwordx4 v44, s[12:15], s47 offen lds
    s_add_u32 m0, s49, 3072
    s_mov_b32 s47, 774144
    buffer_load_dwordx4 v44, s[12:15], s47 offen lds
    s_mov_b32 s48, 64512
    buffer_load_dword v58, v46, s[16:19], s48 offen
    buffer_load_dword v59, v46, s[20:23], s48 offen
    s_add_u32 m0, s49, 4096
    s_mov_b32 s47, 802816
    buffer_load_dwordx4 v44, s[12:15], s47 offen lds
    s_add_u32 m0, s49, 5120
    s_mov_b32 s47, 831488
    buffer_load_dwordx4 v44, s[12:15], s47 offen lds
    s_add_u32 m0, s49, 6144
    s_mov_b32 s47, 1419264
    buffer_load_dwordx4 v45, s[12:15], s47 offen lds
    s_mov_b32 s48, 114688
    buffer_load_dword v163, v48, s[16:19], s48 offen
    buffer_load_dword v164, v48, s[20:23], s48 offen
    s_add_u32 m0, s42, 0
    s_add_u32 s51, s57, 0
    buffer_load_dwordx4 v170, s[8:11], s57 offen lds
    s_add_u32 m0, s42, 1040
    s_add_u32 s51, s57, 2040
    buffer_load_dwordx4 v170, s[8:11], s51 offen lds
    s_add_u32 m0, s42, 2080
    s_add_u32 s51, s57, 4080
    buffer_load_dwordx4 v170, s[8:11], s51 offen lds
    s_add_u32 m0, s42, 3120
    s_add_u32 s51, s57, 6120
    buffer_load_dwordx4 v170, s[8:11], s51 offen lds
    s_add_u32 m0, s42, 4160
    s_add_u32 s51, s57, 8160
    buffer_load_dwordx4 v170, s[8:11], s51 offen lds
    s_add_u32 m0, s42, 5200
    s_add_u32 s51, s57, 10200
    buffer_load_dwordx4 v170, s[8:11], s51 offen lds
    s_add_u32 m0, s42, 6240
    s_add_u32 s51, s57, 12240
    buffer_load_dwordx4 v170, s[8:11], s51 offen lds
    s_add_u32 m0, s42, 7280
    s_add_u32 s51, s57, 14280
    buffer_load_dwordx4 v170, s[8:11], s51 offen lds
    s_waitcnt vmcnt(20)
    ds_read_b64 v[100:101], v47 offset:0
    s_waitcnt vmcnt(19)
    s_waitcnt vmcnt(18)
    v_lshlrev_b32 v159, 16, v56
    v_lshlrev_b32 v160, 16, v57
    v_mul_f32 v144, s34, v159
    v_mul_f32 v148, v160, v159
    v_mul_f32 v147, 2.0, v144
    v_mul_f32 v143, 4.0, v147
    v_mul_f32 v146, 2.0, v143
    v_mul_f32 v142, 4.0, v146
    v_mul_f32 v145, 2.0, v142
    s_waitcnt lgkmcnt(0)
    v_add_u32 v135, v100, v100
    v_lshrrev_b32 v137, 8, v100
    v_and_b32 v133, v156, v135
    v_and_b32 v134, v157, v135
    v_and_b32 v135, v158, v135
    v_and_b32 v136, v156, v137
    v_and_b32 v137, v157, v137
    v_fma_mix_f32 v138, v133, v142, -v148 op_sel:[0,0,0] op_sel_hi:[1,0,0]
    v_fma_mix_f32 v139, v134, v143, -v148 op_sel:[0,0,0] op_sel_hi:[1,0,0]
    v_add_u32 v130, v101, v101
    v_fma_mix_f32 v140, v135, v144, -v148 op_sel:[0,0,0] op_sel_hi:[1,0,0]
    v_fma_mix_f32 v141, v136, v142, -v148 op_sel:[0,0,0] op_sel_hi:[1,0,0]
    v_lshrrev_b32 v132, 8, v101
    v_cvt_pk_bf16_f32 v0, v138, v139
    v_fma_mix_f32 v138, v137, v143, -v148 op_sel:[0,0,0] op_sel_hi:[1,0,0]
    v_and_b32 v128, v156, v130
    ds_read_b64 v[102:103], v47 offset:512
    v_fma_mix_f32 v139, v133, v145, -v148 op_sel:[1,0,0] op_sel_hi:[1,0,0]
    v_cvt_pk_bf16_f32 v1, v140, v141
    v_and_b32 v129, v157, v130
    v_fma_mix_f32 v140, v134, v146, -v148 op_sel:[1,0,0] op_sel_hi:[1,0,0]
    v_fma_mix_f32 v141, v135, v147, -v148 op_sel:[1,0,0] op_sel_hi:[1,0,0]
    v_and_b32 v130, v158, v130
    v_cvt_pk_bf16_f32 v2, v138, v139
    v_fma_mix_f32 v138, v136, v145, -v148 op_sel:[1,0,0] op_sel_hi:[1,0,0]
    v_and_b32 v131, v156, v132
    v_fma_mix_f32 v139, v137, v146, -v148 op_sel:[1,0,0] op_sel_hi:[1,0,0]
    v_cvt_pk_bf16_f32 v3, v140, v141
    v_and_b32 v132, v157, v132
    v_cvt_pk_bf16_f32 v4, v138, v139
    v_and_b32 v159, s52, v56
    v_and_b32 v160, s52, v57
    v_mul_f32 v151, s34, v159
    v_mul_f32 v155, v160, v159
    v_mul_f32 v154, 2.0, v151
    v_mul_f32 v150, 4.0, v154
    v_mul_f32 v153, 2.0, v150
    s_waitcnt lgkmcnt(0)
    s_barrier
    v_mul_f32 v149, 4.0, v153
    v_mul_f32 v152, 2.0, v149
    v_fma_mix_f32 v138, v128, v149, -v155 op_sel:[0,0,0] op_sel_hi:[1,0,0]
    v_fma_mix_f32 v139, v129, v150, -v155 op_sel:[0,0,0] op_sel_hi:[1,0,0]
    v_add_u32 v135, v102, v102
    v_fma_mix_f32 v140, v130, v151, -v155 op_sel:[0,0,0] op_sel_hi:[1,0,0]
    v_fma_mix_f32 v141, v131, v149, -v155 op_sel:[0,0,0] op_sel_hi:[1,0,0]
    v_lshrrev_b32 v137, 8, v102
    v_cvt_pk_bf16_f32 v64, v138, v139
    v_fma_mix_f32 v138, v132, v150, -v155 op_sel:[0,0,0] op_sel_hi:[1,0,0]
    v_and_b32 v133, v156, v135
    v_fma_mix_f32 v139, v128, v152, -v155 op_sel:[1,0,0] op_sel_hi:[1,0,0]
    v_cvt_pk_bf16_f32 v65, v140, v141
    v_and_b32 v134, v157, v135
    v_fma_mix_f32 v140, v129, v153, -v155 op_sel:[1,0,0] op_sel_hi:[1,0,0]
    v_fma_mix_f32 v141, v130, v154, -v155 op_sel:[1,0,0] op_sel_hi:[1,0,0]
    v_and_b32 v135, v158, v135
    v_cvt_pk_bf16_f32 v66, v138, v139
    v_fma_mix_f32 v138, v131, v152, -v155 op_sel:[1,0,0] op_sel_hi:[1,0,0]
    v_and_b32 v136, v156, v137
    v_fma_mix_f32 v139, v132, v153, -v155 op_sel:[1,0,0] op_sel_hi:[1,0,0]
    v_cvt_pk_bf16_f32 v67, v140, v141
    v_and_b32 v137, v157, v137
    v_cvt_pk_bf16_f32 v68, v138, v139
    s_waitcnt vmcnt(17)
    ds_read_b64 v[104:105], v47 offset:1024
    v_fma_mix_f32 v138, v133, v142, -v148 op_sel:[0,0,0] op_sel_hi:[1,0,0]
    v_fma_mix_f32 v139, v134, v143, -v148 op_sel:[0,0,0] op_sel_hi:[1,0,0]
    v_add_u32 v130, v103, v103
    v_fma_mix_f32 v140, v135, v144, -v148 op_sel:[0,0,0] op_sel_hi:[1,0,0]
    v_fma_mix_f32 v141, v136, v142, -v148 op_sel:[0,0,0] op_sel_hi:[1,0,0]
    v_lshrrev_b32 v132, 8, v103
    ds_read_b64 v[106:107], v47 offset:1536
    v_cvt_pk_bf16_f32 v5, v138, v139
    v_fma_mix_f32 v138, v137, v143, -v148 op_sel:[0,0,0] op_sel_hi:[1,0,0]
    v_and_b32 v128, v156, v130
    v_fma_mix_f32 v139, v133, v145, -v148 op_sel:[1,0,0] op_sel_hi:[1,0,0]
    v_cvt_pk_bf16_f32 v6, v140, v141
    s_waitcnt vmcnt(16)
    ds_read_b64 v[108:109], v47 offset:2048
    v_and_b32 v129, v157, v130
    v_fma_mix_f32 v140, v134, v146, -v148 op_sel:[1,0,0] op_sel_hi:[1,0,0]
    v_fma_mix_f32 v141, v135, v147, -v148 op_sel:[1,0,0] op_sel_hi:[1,0,0]
    v_and_b32 v130, v158, v130
    v_cvt_pk_bf16_f32 v7, v138, v139
    ds_read_b64 v[110:111], v47 offset:2560
    v_fma_mix_f32 v138, v136, v145, -v148 op_sel:[1,0,0] op_sel_hi:[1,0,0]
    v_and_b32 v131, v156, v132
    v_fma_mix_f32 v139, v137, v146, -v148 op_sel:[1,0,0] op_sel_hi:[1,0,0]
    v_cvt_pk_bf16_f32 v8, v140, v141
    v_and_b32 v132, v157, v132
    s_waitcnt vmcnt(15)
    ds_read_b64 v[112:113], v47 offset:3072
    v_cvt_pk_bf16_f32 v9, v138, v139
    v_fma_mix_f32 v138, v128, v149, -v155 op_sel:[0,0,0] op_sel_hi:[1,0,0]
    v_fma_mix_f32 v139, v129, v150, -v155 op_sel:[0,0,0] op_sel_hi:[1,0,0]
    s_waitcnt lgkmcnt(4)
    v_add_u32 v135, v104, v104
    v_fma_mix_f32 v140, v130, v151, -v155 op_sel:[0,0,0] op_sel_hi:[1,0,0]
    ds_read_b64 v[114:115], v47 offset:3584
    v_fma_mix_f32 v141, v131, v149, -v155 op_sel:[0,0,0] op_sel_hi:[1,0,0]
    v_lshrrev_b32 v137, 8, v104
    v_cvt_pk_bf16_f32 v69, v138, v139
    v_fma_mix_f32 v138, v132, v150, -v155 op_sel:[0,0,0] op_sel_hi:[1,0,0]
    v_and_b32 v133, v156, v135
    s_waitcnt vmcnt(12)
    ds_read_b64 v[116:117], v47 offset:4096
    v_fma_mix_f32 v139, v128, v152, -v155 op_sel:[1,0,0] op_sel_hi:[1,0,0]
    v_cvt_pk_bf16_f32 v70, v140, v141
    v_and_b32 v134, v157, v135
    v_fma_mix_f32 v140, v129, v153, -v155 op_sel:[1,0,0] op_sel_hi:[1,0,0]
    v_fma_mix_f32 v141, v130, v154, -v155 op_sel:[1,0,0] op_sel_hi:[1,0,0]
    ds_read_b64 v[118:119], v47 offset:4608
    v_and_b32 v135, v158, v135
    v_cvt_pk_bf16_f32 v71, v138, v139
    v_fma_mix_f32 v138, v131, v152, -v155 op_sel:[1,0,0] op_sel_hi:[1,0,0]
    v_and_b32 v136, v156, v137
    v_fma_mix_f32 v139, v132, v153, -v155 op_sel:[1,0,0] op_sel_hi:[1,0,0]
    s_waitcnt vmcnt(11)
    ds_read_b64 v[120:121], v47 offset:5120
    v_cvt_pk_bf16_f32 v72, v140, v141
    v_and_b32 v137, v157, v137
    v_cvt_pk_bf16_f32 v73, v138, v139
    v_fma_mix_f32 v138, v133, v142, -v148 op_sel:[0,0,0] op_sel_hi:[1,0,0]
    v_fma_mix_f32 v139, v134, v143, -v148 op_sel:[0,0,0] op_sel_hi:[1,0,0]
    ds_read_b64 v[122:123], v47 offset:5632
    v_add_u32 v130, v105, v105
    v_fma_mix_f32 v140, v135, v144, -v148 op_sel:[0,0,0] op_sel_hi:[1,0,0]
    v_fma_mix_f32 v141, v136, v142, -v148 op_sel:[0,0,0] op_sel_hi:[1,0,0]
    v_lshrrev_b32 v132, 8, v105
    v_cvt_pk_bf16_f32 v10, v138, v139
    s_waitcnt vmcnt(10)
    ds_read_b64 v[124:125], v47 offset:6144
    v_fma_mix_f32 v138, v137, v143, -v148 op_sel:[0,0,0] op_sel_hi:[1,0,0]
    v_and_b32 v128, v156, v130
    v_fma_mix_f32 v139, v133, v145, -v148 op_sel:[1,0,0] op_sel_hi:[1,0,0]
    v_cvt_pk_bf16_f32 v11, v140, v141
    v_and_b32 v129, v157, v130
    ds_read_b64 v[126:127], v47 offset:6656
    v_fma_mix_f32 v140, v134, v146, -v148 op_sel:[1,0,0] op_sel_hi:[1,0,0]
    v_fma_mix_f32 v141, v135, v147, -v148 op_sel:[1,0,0] op_sel_hi:[1,0,0]
    v_and_b32 v130, v158, v130
    v_cvt_pk_bf16_f32 v12, v138, v139
    v_fma_mix_f32 v138, v136, v145, -v148 op_sel:[1,0,0] op_sel_hi:[1,0,0]
    v_and_b32 v131, v156, v132
    v_fma_mix_f32 v139, v137, v146, -v148 op_sel:[1,0,0] op_sel_hi:[1,0,0]
    v_cvt_pk_bf16_f32 v13, v140, v141
    v_and_b32 v132, v157, v132
    v_cvt_pk_bf16_f32 v14, v138, v139
    v_fma_mix_f32 v138, v128, v149, -v155 op_sel:[0,0,0] op_sel_hi:[1,0,0]
    v_fma_mix_f32 v139, v129, v150, -v155 op_sel:[0,0,0] op_sel_hi:[1,0,0]
    s_waitcnt lgkmcnt(10)
    v_add_u32 v135, v106, v106
    v_fma_mix_f32 v140, v130, v151, -v155 op_sel:[0,0,0] op_sel_hi:[1,0,0]
    v_fma_mix_f32 v141, v131, v149, -v155 op_sel:[0,0,0] op_sel_hi:[1,0,0]
    v_lshrrev_b32 v137, 8, v106
    v_cvt_pk_bf16_f32 v74, v138, v139
    v_fma_mix_f32 v138, v132, v150, -v155 op_sel:[0,0,0] op_sel_hi:[1,0,0]
    v_and_b32 v133, v156, v135
    v_fma_mix_f32 v139, v128, v152, -v155 op_sel:[1,0,0] op_sel_hi:[1,0,0]
    v_cvt_pk_bf16_f32 v75, v140, v141
    v_and_b32 v134, v157, v135
    v_fma_mix_f32 v140, v129, v153, -v155 op_sel:[1,0,0] op_sel_hi:[1,0,0]
    v_fma_mix_f32 v141, v130, v154, -v155 op_sel:[1,0,0] op_sel_hi:[1,0,0]
    v_and_b32 v135, v158, v135
    s_waitcnt vmcnt(0) lgkmcnt(0)
    s_barrier
    v_cvt_pk_bf16_f32 v76, v138, v139
    v_fma_mix_f32 v138, v131, v152, -v155 op_sel:[1,0,0] op_sel_hi:[1,0,0]
    v_and_b32 v136, v156, v137
    v_fma_mix_f32 v139, v132, v153, -v155 op_sel:[1,0,0] op_sel_hi:[1,0,0]
    v_cvt_pk_bf16_f32 v77, v140, v141
    v_and_b32 v137, v157, v137
    v_cvt_pk_bf16_f32 v78, v138, v139
    v_fma_mix_f32 v138, v133, v142, -v148 op_sel:[0,0,0] op_sel_hi:[1,0,0]
    v_fma_mix_f32 v139, v134, v143, -v148 op_sel:[0,0,0] op_sel_hi:[1,0,0]
    v_add_u32 v130, v107, v107
    v_fma_mix_f32 v140, v135, v144, -v148 op_sel:[0,0,0] op_sel_hi:[1,0,0]
    v_fma_mix_f32 v141, v136, v142, -v148 op_sel:[0,0,0] op_sel_hi:[1,0,0]
    v_lshrrev_b32 v132, 8, v107
    v_cvt_pk_bf16_f32 v15, v138, v139
    v_fma_mix_f32 v138, v137, v143, -v148 op_sel:[0,0,0] op_sel_hi:[1,0,0]
    v_and_b32 v128, v156, v130
    v_fma_mix_f32 v139, v133, v145, -v148 op_sel:[1,0,0] op_sel_hi:[1,0,0]
    v_cvt_pk_bf16_f32 v16, v140, v141
    v_and_b32 v129, v157, v130
    v_fma_mix_f32 v140, v134, v146, -v148 op_sel:[1,0,0] op_sel_hi:[1,0,0]
    v_fma_mix_f32 v141, v135, v147, -v148 op_sel:[1,0,0] op_sel_hi:[1,0,0]
    v_and_b32 v130, v158, v130
    v_cvt_pk_bf16_f32 v17, v138, v139
    v_fma_mix_f32 v138, v136, v145, -v148 op_sel:[1,0,0] op_sel_hi:[1,0,0]
    v_and_b32 v131, v156, v132
    v_fma_mix_f32 v139, v137, v146, -v148 op_sel:[1,0,0] op_sel_hi:[1,0,0]
    v_cvt_pk_bf16_f32 v18, v140, v141
    v_and_b32 v132, v157, v132
    v_cvt_pk_bf16_f32 v19, v138, v139
    v_fma_mix_f32 v138, v128, v149, -v155 op_sel:[0,0,0] op_sel_hi:[1,0,0]
    v_fma_mix_f32 v139, v129, v150, -v155 op_sel:[0,0,0] op_sel_hi:[1,0,0]
    v_add_u32 v135, v108, v108
    v_fma_mix_f32 v140, v130, v151, -v155 op_sel:[0,0,0] op_sel_hi:[1,0,0]
    v_fma_mix_f32 v141, v131, v149, -v155 op_sel:[0,0,0] op_sel_hi:[1,0,0]
    v_lshrrev_b32 v137, 8, v108
    v_cvt_pk_bf16_f32 v79, v138, v139
    v_fma_mix_f32 v138, v132, v150, -v155 op_sel:[0,0,0] op_sel_hi:[1,0,0]
    v_and_b32 v133, v156, v135
    v_fma_mix_f32 v139, v128, v152, -v155 op_sel:[1,0,0] op_sel_hi:[1,0,0]
    v_cvt_pk_bf16_f32 v80, v140, v141
    v_and_b32 v134, v157, v135
    v_fma_mix_f32 v140, v129, v153, -v155 op_sel:[1,0,0] op_sel_hi:[1,0,0]
    v_fma_mix_f32 v141, v130, v154, -v155 op_sel:[1,0,0] op_sel_hi:[1,0,0]
    v_and_b32 v135, v158, v135
    v_cvt_pk_bf16_f32 v81, v138, v139
    v_fma_mix_f32 v138, v131, v152, -v155 op_sel:[1,0,0] op_sel_hi:[1,0,0]
    v_and_b32 v136, v156, v137
    v_fma_mix_f32 v139, v132, v153, -v155 op_sel:[1,0,0] op_sel_hi:[1,0,0]
    v_cvt_pk_bf16_f32 v82, v140, v141
    v_and_b32 v137, v157, v137
    v_cvt_pk_bf16_f32 v83, v138, v139
    v_fma_mix_f32 v138, v133, v142, -v148 op_sel:[0,0,0] op_sel_hi:[1,0,0]
    v_fma_mix_f32 v139, v134, v143, -v148 op_sel:[0,0,0] op_sel_hi:[1,0,0]
    v_add_u32 v130, v109, v109
    v_fma_mix_f32 v140, v135, v144, -v148 op_sel:[0,0,0] op_sel_hi:[1,0,0]
    v_fma_mix_f32 v141, v136, v142, -v148 op_sel:[0,0,0] op_sel_hi:[1,0,0]
    v_lshrrev_b32 v132, 8, v109
    v_cvt_pk_bf16_f32 v20, v138, v139
    v_fma_mix_f32 v138, v137, v143, -v148 op_sel:[0,0,0] op_sel_hi:[1,0,0]
    v_and_b32 v128, v156, v130
    v_fma_mix_f32 v139, v133, v145, -v148 op_sel:[1,0,0] op_sel_hi:[1,0,0]
    v_cvt_pk_bf16_f32 v21, v140, v141
    v_and_b32 v129, v157, v130
    v_fma_mix_f32 v140, v134, v146, -v148 op_sel:[1,0,0] op_sel_hi:[1,0,0]
    v_fma_mix_f32 v141, v135, v147, -v148 op_sel:[1,0,0] op_sel_hi:[1,0,0]
    v_and_b32 v130, v158, v130
    v_cvt_pk_bf16_f32 v22, v138, v139
    v_fma_mix_f32 v138, v136, v145, -v148 op_sel:[1,0,0] op_sel_hi:[1,0,0]
    v_and_b32 v131, v156, v132
    v_fma_mix_f32 v139, v137, v146, -v148 op_sel:[1,0,0] op_sel_hi:[1,0,0]
    v_cvt_pk_bf16_f32 v23, v140, v141
    v_and_b32 v132, v157, v132
    v_cvt_pk_bf16_f32 v24, v138, v139
    v_fma_mix_f32 v138, v128, v149, -v155 op_sel:[0,0,0] op_sel_hi:[1,0,0]
    v_fma_mix_f32 v139, v129, v150, -v155 op_sel:[0,0,0] op_sel_hi:[1,0,0]
    v_add_u32 v135, v110, v110
    v_fma_mix_f32 v140, v130, v151, -v155 op_sel:[0,0,0] op_sel_hi:[1,0,0]
    v_fma_mix_f32 v141, v131, v149, -v155 op_sel:[0,0,0] op_sel_hi:[1,0,0]
    v_lshrrev_b32 v137, 8, v110
    v_cvt_pk_bf16_f32 v84, v138, v139
    v_fma_mix_f32 v138, v132, v150, -v155 op_sel:[0,0,0] op_sel_hi:[1,0,0]
L_pad3:
    s_cbranch_execz L_ret
    v_and_b32 v133, v156, v135
    v_fma_mix_f32 v139, v128, v152, -v155 op_sel:[1,0,0] op_sel_hi:[1,0,0]
    v_cvt_pk_bf16_f32 v85, v140, v141
    v_and_b32 v134, v157, v135
    v_fma_mix_f32 v140, v129, v153, -v155 op_sel:[1,0,0] op_sel_hi:[1,0,0]
    v_fma_mix_f32 v141, v130, v154, -v155 op_sel:[1,0,0] op_sel_hi:[1,0,0]
    v_and_b32 v135, v158, v135
    v_cvt_pk_bf16_f32 v86, v138, v139
    v_fma_mix_f32 v138, v131, v152, -v155 op_sel:[1,0,0] op_sel_hi:[1,0,0]
    v_and_b32 v136, v156, v137
    v_fma_mix_f32 v139, v132, v153, -v155 op_sel:[1,0,0] op_sel_hi:[1,0,0]
    v_cvt_pk_bf16_f32 v87, v140, v141
    v_and_b32 v137, v157, v137
    v_cvt_pk_bf16_f32 v88, v138, v139
    v_fma_mix_f32 v138, v133, v142, -v148 op_sel:[0,0,0] op_sel_hi:[1,0,0]
    v_fma_mix_f32 v139, v134, v143, -v148 op_sel:[0,0,0] op_sel_hi:[1,0,0]
    v_add_u32 v130, v111, v111
    v_fma_mix_f32 v140, v135, v144, -v148 op_sel:[0,0,0] op_sel_hi:[1,0,0]
    v_fma_mix_f32 v141, v136, v142, -v148 op_sel:[0,0,0] op_sel_hi:[1,0,0]
    v_lshrrev_b32 v132, 8, v111
    v_cvt_pk_bf16_f32 v25, v138, v139
    v_fma_mix_f32 v138, v137, v143, -v148 op_sel:[0,0,0] op_sel_hi:[1,0,0]
    v_and_b32 v128, v156, v130
    v_fma_mix_f32 v139, v133, v145, -v148 op_sel:[1,0,0] op_sel_hi:[1,0,0]
    v_cvt_pk_bf16_f32 v26, v140, v141
    v_and_b32 v129, v157, v130
    v_fma_mix_f32 v140, v134, v146, -v148 op_sel:[1,0,0] op_sel_hi:[1,0,0]
    v_fma_mix_f32 v141, v135, v147, -v148 op_sel:[1,0,0] op_sel_hi:[1,0,0]
    v_and_b32 v130, v158, v130
    v_cvt_pk_bf16_f32 v27, v138, v139
    v_fma_mix_f32 v138, v136, v145, -v148 op_sel:[1,0,0] op_sel_hi:[1,0,0]
    s_barrier
    v_and_b32 v131, v156, v132
    v_fma_mix_f32 v139, v137, v146, -v148 op_sel:[1,0,0] op_sel_hi:[1,0,0]
    v_cvt_pk_bf16_f32 v28, v140, v141
    v_and_b32 v132, v157, v132
    v_cvt_pk_bf16_f32 v29, v138, v139
    v_fma_mix_f32 v138, v128, v149, -v155 op_sel:[0,0,0] op_sel_hi:[1,0,0]
    v_fma_mix_f32 v139, v129, v150, -v155 op_sel:[0,0,0] op_sel_hi:[1,0,0]
    v_add_u32 v135, v112, v112
    v_fma_mix_f32 v140, v130, v151, -v155 op_sel:[0,0,0] op_sel_hi:[1,0,0]
    v_fma_mix_f32 v141, v131, v149, -v155 op_sel:[0,0,0] op_sel_hi:[1,0,0]
    v_lshrrev_b32 v137, 8, v112
    v_cvt_pk_bf16_f32 v89, v138, v139
    v_fma_mix_f32 v138, v132, v150, -v155 op_sel:[0,0,0] op_sel_hi:[1,0,0]
    v_and_b32 v133, v156, v135
    v_fma_mix_f32 v139, v128, v152, -v155 op_sel:[1,0,0] op_sel_hi:[1,0,0]
    v_cvt_pk_bf16_f32 v90, v140, v141
    v_and_b32 v134, v157, v135
    v_fma_mix_f32 v140, v129, v153, -v155 op_sel:[1,0,0] op_sel_hi:[1,0,0]
    v_fma_mix_f32 v141, v130, v154, -v155 op_sel:[1,0,0] op_sel_hi:[1,0,0]
    v_and_b32 v135, v158, v135
    v_cvt_pk_bf16_f32 v91, v138, v139
    v_fma_mix_f32 v138, v131, v152, -v155 op_sel:[1,0,0] op_sel_hi:[1,0,0]
    v_and_b32 v136, v156, v137
    v_fma_mix_f32 v139, v132, v153, -v155 op_sel:[1,0,0] op_sel_hi:[1,0,0]
    v_cvt_pk_bf16_f32 v92, v140, v141
    v_and_b32 v137, v157, v137
    v_cvt_pk_bf16_f32 v93, v138, v139
    v_lshlrev_b32 v159, 16, v58
    v_lshlrev_b32 v160, 16, v59
    v_mul_f32 v144, s34, v159
    s_cmp_eq_u32 s41, 0
    s_cbranch_scc1 L_nxf
    s_lshr_b32 s45, s42, 1
    s_add_u32 m0, s45, 133120
    s_add_u32 s51, s61, 0
    buffer_load_dwordx4 v170, s[8:11], s51 offen lds
    s_add_u32 m0, s45, 134160
    s_add_u32 s51, s61, 2040
    buffer_load_dwordx4 v170, s[8:11], s51 offen lds
    s_add_u32 m0, s45, 135200
    s_add_u32 s51, s61, 4080
    buffer_load_dwordx4 v170, s[8:11], s51 offen lds
    s_add_u32 m0, s45, 136240
    s_add_u32 s51, s61, 6120
    buffer_load_dwordx4 v170, s[8:11], s51 offen lds
L_nxf:
    v_mul_f32 v148, v160, v159
    v_mul_f32 v147, 2.0, v144
    v_mul_f32 v143, 4.0, v147
    v_mul_f32 v146, 2.0, v143
    v_mul_f32 v142, 4.0, v146
    v_mul_f32 v145, 2.0, v142
    v_fma_mix_f32 v138, v133, v142, -v148 op_sel:[0,0,0] op_sel_hi:[1,0,0]
    v_fma_mix_f32 v139, v134, v143, -v148 op_sel:[0,0,0] op_sel_hi:[1,0,0]
    v_add_u32 v130, v113, v113
    v_fma_mix_f32 v140, v135, v144, -v148 op_sel:[0,0,0] op_sel_hi:[1,0,0]
    v_fma_mix_f32 v141, v136, v142, -v148 op_sel:[0,0,0] op_sel_hi:[1,0,0]
    v_lshrrev_b32 v132, 8, v113
    v_cvt_pk_bf16_f32 v30, v138, v139
    v_fma_mix_f32 v138, v137, v143, -v148 op_sel:[0,0,0] op_sel_hi:[1,0,0]
    v_and_b32 v128, v156, v130
    v_fma_mix_f32 v139, v133, v145, -v148 op_sel:[1,0,0] op_sel_hi:[1,0,0]
    v_cvt_pk_bf16_f32 v31, v140, v141
    v_and_b32 v129, v157, v130
    v_fma_mix_f32 v140, v134, v146, -v148 op_sel:[1,0,0] op_sel_hi:[1,0,0]
    v_fma_mix_f32 v141, v135, v147, -v148 op_sel:[1,0,0] op_sel_hi:[1,0,0]
    v_and_b32 v130, v158, v130
    v_cvt_pk_bf16_f32 v32, v138, v139
    v_fma_mix_f32 v138, v136, v145, -v148 op_sel:[1,0,0] op_sel_hi:[1,0,0]
    v_and_b32 v131, v156, v132
    v_fma_mix_f32 v139, v137, v146, -v148 op_sel:[1,0,0] op_sel_hi:[1,0,0]
    v_cvt_pk_bf16_f32 v33, v140, v141
    v_and_b32 v132, v157, v132
    v_cvt_pk_bf16_f32 v34, v138, v139
    v_and_b32 v159, s52, v58
    v_and_b32 v160, s52, v59
    v_mul_f32 v151, s34, v159
    v_mul_f32 v155, v160, v159
    v_mul_f32 v154, 2.0, v151
    v_mul_f32 v150, 4.0, v154
    v_mul_f32 v153, 2.0, v150
    v_mul_f32 v149, 4.0, v153
    v_mul_f32 v152, 2.0, v149
    v_fma_mix_f32 v138, v128, v149, -v155 op_sel:[0,0,0] op_sel_hi:[1,0,0]
    v_fma_mix_f32 v139, v129, v150, -v155 op_sel:[0,0,0] op_sel_hi:[1,0,0]
    v_add_u32 v135, v114, v114
    v_fma_mix_f32 v140, v130, v151, -v155 op_sel:[0,0,0] op_sel_hi:[1,0,0]
    v_fma_mix_f32 v141, v131, v149, -v155 op_sel:[0,0,0] op_sel_hi:[1,0,0]
    v_lshrrev_b32 v137, 8, v114
    v_cvt_pk_bf16_f32 v94, v138, v139
    v_fma_mix_f32 v138, v132, v150, -v155 op_sel:[0,0,0] op_sel_hi:[1,0,0]
    v_and_b32 v133, v156, v135
    v_fma_mix_f32 v139, v128, v152, -v155 op_sel:[1,0,0] op_sel_hi:[1,0,0]
    v_cvt_pk_bf16_f32 v95, v140, v141
    v_and_b32 v134, v157, v135
    v_fma_mix_f32 v140, v129, v153, -v155 op_sel:[1,0,0] op_sel_hi:[1,0,0]
    v_fma_mix_f32 v141, v130, v154, -v155 op_sel:[1,0,0] op_sel_hi:[1,0,0]
    v_and_b32 v135, v158, v135
    v_cvt_pk_bf16_f32 v96, v138, v139
    v_fma_mix_f32 v138, v131, v152, -v155 op_sel:[1,0,0] op_sel_hi:[1,0,0]
    v_and_b32 v136, v156, v137
    v_fma_mix_f32 v139, v132, v153, -v155 op_sel:[1,0,0] op_sel_hi:[1,0,0]
    v_cvt_pk_bf16_f32 v97, v140, v141
    v_and_b32 v137, v157, v137
    v_cvt_pk_bf16_f32 v98, v138, v139
    v_fma_mix_f32 v138, v133, v142, -v148 op_sel:[0,0,0] op_sel_hi:[1,0,0]
    v_fma_mix_f32 v139, v134, v143, -v148 op_sel:[0,0,0] op_sel_hi:[1,0,0]
    v_add_u32 v130, v115, v115
    v_fma_mix_f32 v140, v135, v144, -v148 op_sel:[0,0,0] op_sel_hi:[1,0,0]
    v_fma_mix_f32 v141, v136, v142, -v148 op_sel:[0,0,0] op_sel_hi:[1,0,0]
    v_lshrrev_b32 v132, 8, v115
    v_cvt_pk_bf16_f32 v35, v138, v139
    v_fma_mix_f32 v138, v137, v143, -v148 op_sel:[0,0,0] op_sel_hi:[1,0,0]
    v_and_b32 v128, v156, v130
    v_fma_mix_f32 v139, v133, v145, -v148 op_sel:[1,0,0] op_sel_hi:[1,0,0]
    v_cvt_pk_bf16_f32 v36, v140, v141
    s_barrier
    v_and_b32 v129, v157, v130
    v_fma_mix_f32 v140, v134, v146, -v148 op_sel:[1,0,0] op_sel_hi:[1,0,0]
    v_fma_mix_f32 v141, v135, v147, -v148 op_sel:[1,0,0] op_sel_hi:[1,0,0]
    v_and_b32 v130, v158, v130
    v_cvt_pk_bf16_f32 v37, v138, v139
    v_fma_mix_f32 v138, v136, v145, -v148 op_sel:[1,0,0] op_sel_hi:[1,0,0]
    v_and_b32 v131, v156, v132
    v_fma_mix_f32 v139, v137, v146, -v148 op_sel:[1,0,0] op_sel_hi:[1,0,0]
    v_cvt_pk_bf16_f32 v38, v140, v141
    v_and_b32 v132, v157, v132
    v_cvt_pk_bf16_f32 v39, v138, v139
    v_fma_mix_f32 v138, v128, v149, -v155 op_sel:[0,0,0] op_sel_hi:[1,0,0]
    v_fma_mix_f32 v139, v129, v150, -v155 op_sel:[0,0,0] op_sel_hi:[1,0,0]
    v_add_u32 v135, v116, v116
    v_fma_mix_f32 v140, v130, v151, -v155 op_sel:[0,0,0] op_sel_hi:[1,0,0]
    v_fma_mix_f32 v141, v131, v149, -v155 op_sel:[0,0,0] op_sel_hi:[1,0,0]
    v_lshrrev_b32 v137, 8, v116
    v_cvt_pk_bf16_f32 v99, v138, v139
    v_fma_mix_f32 v138, v132, v150, -v155 op_sel:[0,0,0] op_sel_hi:[1,0,0]
    v_and_b32 v133, v156, v135
    v_fma_mix_f32 v139, v128, v152, -v155 op_sel:[1,0,0] op_sel_hi:[1,0,0]
    v_cvt_pk_bf16_f32 v100, v140, v141
    v_and_b32 v134, v157, v135
    v_fma_mix_f32 v140, v129, v153, -v155 op_sel:[1,0,0] op_sel_hi:[1,0,0]
    v_fma_mix_f32 v141, v130, v154, -v155 op_sel:[1,0,0] op_sel_hi:[1,0,0]
    v_and_b32 v135, v158, v135
    v_cvt_pk_bf16_f32 v101, v138, v139
    v_fma_mix_f32 v138, v131, v152, -v155 op_sel:[1,0,0] op_sel_hi:[1,0,0]
    v_and_b32 v136, v156, v137
    v_fma_mix_f32 v139, v132, v153, -v155 op_sel:[1,0,0] op_sel_hi:[1,0,0]
    v_cvt_pk_bf16_f32 v102, v140, v141
    v_and_b32 v137, v157, v137
    v_cvt_pk_bf16_f32 v103, v138, v139
    v_fma_mix_f32 v138, v133, v142, -v148 op_sel:[0,0,0] op_sel_hi:[1,0,0]
    v_fma_mix_f32 v139, v134, v143, -v148 op_sel:[0,0,0] op_sel_hi:[1,0,0]
    v_add_u32 v130, v117, v117
    v_fma_mix_f32 v140, v135, v144, -v148 op_sel:[0,0,0] op_sel_hi:[1,0,0]
    v_fma_mix_f32 v141, v136, v142, -v148 op_sel:[0,0,0] op_sel_hi:[1,0,0]
    v_lshrrev_b32 v132, 8, v117
    v_cvt_pk_bf16_f32 v40, v138, v139
    v_fma_mix_f32 v138, v137, v143, -v148 op_sel:[0,0,0] op_sel_hi:[1,0,0]
    v_and_b32 v128, v156, v130
    v_fma_mix_f32 v139, v133, v145, -v148 op_sel:[1,0,0] op_sel_hi:[1,0,0]
    v_cvt_pk_bf16_f32 v41, v140, v141
    v_and_b32 v129, v157, v130
    v_fma_mix_f32 v140, v134, v146, -v148 op_sel:[1,0,0] op_sel_hi:[1,0,0]
    v_fma_mix_f32 v141, v135, v147, -v148 op_sel:[1,0,0] op_sel_hi:[1,0,0]
    v_and_b32 v130, v158, v130
    v_cvt_pk_bf16_f32 v42, v138, v139
    v_fma_mix_f32 v138, v136, v145, -v148 op_sel:[1,0,0] op_sel_hi:[1,0,0]
    v_and_b32 v131, v156, v132
    v_fma_mix_f32 v139, v137, v146, -v148 op_sel:[1,0,0] op_sel_hi:[1,0,0]
    v_cvt_pk_bf16_f32 v43, v140, v141
    v_and_b32 v132, v157, v132
    v_cvt_pk_bf16_f32 v44, v138, v139
    v_fma_mix_f32 v138, v128, v149, -v155 op_sel:[0,0,0] op_sel_hi:[1,0,0]
    v_fma_mix_f32 v139, v129, v150, -v155 op_sel:[0,0,0] op_sel_hi:[1,0,0]
    v_add_u32 v135, v118, v118
    v_fma_mix_f32 v140, v130, v151, -v155 op_sel:[0,0,0] op_sel_hi:[1,0,0]
    v_fma_mix_f32 v141, v131, v149, -v155 op_sel:[0,0,0] op_sel_hi:[1,0,0]
    v_lshrrev_b32 v137, 8, v118
    v_cvt_pk_bf16_f32 v104, v138, v139
    v_fma_mix_f32 v138, v132, v150, -v155 op_sel:[0,0,0] op_sel_hi:[1,0,0]
    v_and_b32 v133, v156, v135
    v_fma_mix_f32 v139, v128, v152, -v155 op_sel:[1,0,0] op_sel_hi:[1,0,0]
    v_cvt_pk_bf16_f32 v105, v140, v141
    v_and_b32 v134, v157, v135
    v_fma_mix_f32 v140, v129, v153, -v155 op_sel:[1,0,0] op_sel_hi:[1,0,0]
    v_fma_mix_f32 v141, v130, v154, -v155 op_sel:[1,0,0] op_sel_hi:[1,0,0]
    v_and_b32 v135, v158, v135
    v_cvt_pk_bf16_f32 v106, v138, v139
    v_fma_mix_f32 v138, v131, v152, -v155 op_sel:[1,0,0] op_sel_hi:[1,0,0]
    v_and_b32 v136, v156, v137
    v_fma_mix_f32 v139, v132, v153, -v155 op_sel:[1,0,0] op_sel_hi:[1,0,0]
    v_cvt_pk_bf16_f32 v107, v140, v141
    v_and_b32 v137, v157, v137
    v_cvt_pk_bf16_f32 v108, v138, v139
    v_fma_mix_f32 v138, v133, v142, -v148 op_sel:[0,0,0] op_sel_hi:[1,0,0]
    v_fma_mix_f32 v139, v134, v143, -v148 op_sel:[0,0,0] op_sel_hi:[1,0,0]
    v_add_u32 v130, v119, v119
    v_fma_mix_f32 v140, v135, v144, -v148 op_sel:[0,0,0] op_sel_hi:[1,0,0]
    v_fma_mix_f32 v141, v136, v142, -v148 op_sel:[0,0,0] op_sel_hi:[1,0,0]
    v_lshrrev_b32 v132, 8, v119
    v_cvt_pk_bf16_f32 v45, v138, v139
    v_fma_mix_f32 v138, v137, v143, -v148 op_sel:[0,0,0] op_sel_hi:[1,0,0]
    v_and_b32 v128, v156, v130
    v_fma_mix_f32 v139, v133, v145, -v148 op_sel:[1,0,0] op_sel_hi:[1,0,0]
    v_cvt_pk_bf16_f32 v46, v140, v141
    v_and_b32 v129, v157, v130
    v_fma_mix_f32 v140, v134, v146, -v148 op_sel:[1,0,0] op_sel_hi:[1,0,0]
    v_fma_mix_f32 v141, v135, v147, -v148 op_sel:[1,0,0] op_sel_hi:[1,0,0]
    v_and_b32 v130, v158, v130
    v_cvt_pk_bf16_f32 v47, v138, v139
    v_fma_mix_f32 v138, v136, v145, -v148 op_sel:[1,0,0] op_sel_hi:[1,0,0]
    v_and_b32 v131, v156, v132
    v_fma_mix_f32 v139, v137, v146, -v148 op_sel:[1,0,0] op_sel_hi:[1,0,0]
    v_cvt_pk_bf16_f32 v48, v140, v141
    v_and_b32 v132, v157, v132
    v_cvt_pk_bf16_f32 v49, v138, v139
    v_fma_mix_f32 v138, v128, v149, -v155 op_sel:[0,0,0] op_sel_hi:[1,0,0]
    v_fma_mix_f32 v139, v129, v150, -v155 op_sel:[0,0,0] op_sel_hi:[1,0,0]
    v_add_u32 v135, v120, v120
    v_fma_mix_f32 v140, v130, v151, -v155 op_sel:[0,0,0] op_sel_hi:[1,0,0]
    v_fma_mix_f32 v141, v131, v149, -v155 op_sel:[0,0,0] op_sel_hi:[1,0,0]
    v_lshrrev_b32 v137, 8, v120
    v_cvt_pk_bf16_f32 v109, v138, v139
    v_fma_mix_f32 v138, v132, v150, -v155 op_sel:[0,0,0] op_sel_hi:[1,0,0]
    v_and_b32 v133, v156, v135
    v_fma_mix_f32 v139, v128, v152, -v155 op_sel:[1,0,0] op_sel_hi:[1,0,0]
    v_cvt_pk_bf16_f32 v110, v140, v141
    v_and_b32 v134, v157, v135
    v_fma_mix_f32 v140, v129, v153, -v155 op_sel:[1,0,0] op_sel_hi:[1,0,0]
    s_waitcnt vmcnt(0)
    s_barrier
    v_fma_mix_f32 v141, v130, v154, -v155 op_sel:[1,0,0] op_sel_hi:[1,0,0]
    v_and_b32 v135, v158, v135
    v_cvt_pk_bf16_f32 v111, v138, v139
    v_fma_mix_f32 v138, v131, v152, -v155 op_sel:[1,0,0] op_sel_hi:[1,0,0]
    v_and_b32 v136, v156, v137
    v_fma_mix_f32 v139, v132, v153, -v155 op_sel:[1,0,0] op_sel_hi:[1,0,0]
    v_cvt_pk_bf16_f32 v112, v140, v141
    v_and_b32 v137, v157, v137
    v_cvt_pk_bf16_f32 v113, v138, v139
    v_fma_mix_f32 v138, v133, v142, -v148 op_sel:[0,0,0] op_sel_hi:[1,0,0]
    v_fma_mix_f32 v139, v134, v143, -v148 op_sel:[0,0,0] op_sel_hi:[1,0,0]
    v_add_u32 v130, v121, v121
    v_fma_mix_f32 v140, v135, v144, -v148 op_sel:[0,0,0] op_sel_hi:[1,0,0]
    v_fma_mix_f32 v141, v136, v142, -v148 op_sel:[0,0,0] op_sel_hi:[1,0,0]
    v_lshrrev_b32 v132, 8, v121
    v_cvt_pk_bf16_f32 v50, v138, v139
    v_fma_mix_f32 v138, v137, v143, -v148 op_sel:[0,0,0] op_sel_hi:[1,0,0]
    v_and_b32 v128, v156, v130
    v_fma_mix_f32 v139, v133, v145, -v148 op_sel:[1,0,0] op_sel_hi:[1,0,0]
    v_cvt_pk_bf16_f32 v51, v140, v141
    v_and_b32 v129, v157, v130
    v_fma_mix_f32 v140, v134, v146, -v148 op_sel:[1,0,0] op_sel_hi:[1,0,0]
    v_fma_mix_f32 v141, v135, v147, -v148 op_sel:[1,0,0] op_sel_hi:[1,0,0]
    v_and_b32 v130, v158, v130
    v_cvt_pk_bf16_f32 v52, v138, v139
    v_fma_mix_f32 v138, v136, v145, -v148 op_sel:[1,0,0] op_sel_hi:[1,0,0]
    v_and_b32 v131, v156, v132
    v_fma_mix_f32 v139, v137, v146, -v148 op_sel:[1,0,0] op_sel_hi:[1,0,0]
    v_cvt_pk_bf16_f32 v53, v140, v141
    v_and_b32 v132, v157, v132
    v_cvt_pk_bf16_f32 v54, v138, v139
    v_fma_mix_f32 v138, v128, v149, -v155 op_sel:[0,0,0] op_sel_hi:[1,0,0]
    v_fma_mix_f32 v139, v129, v150, -v155 op_sel:[0,0,0] op_sel_hi:[1,0,0]
    v_add_u32 v135, v122, v122
    v_fma_mix_f32 v140, v130, v151, -v155 op_sel:[0,0,0] op_sel_hi:[1,0,0]
    v_fma_mix_f32 v141, v131, v149, -v155 op_sel:[0,0,0] op_sel_hi:[1,0,0]
    v_lshrrev_b32 v137, 8, v122
    v_cvt_pk_bf16_f32 v114, v138, v139
    v_fma_mix_f32 v138, v132, v150, -v155 op_sel:[0,0,0] op_sel_hi:[1,0,0]
    v_and_b32 v133, v156, v135
    v_fma_mix_f32 v139, v128, v152, -v155 op_sel:[1,0,0] op_sel_hi:[1,0,0]
    v_cvt_pk_bf16_f32 v115, v140, v141
    v_and_b32 v134, v157, v135
    v_fma_mix_f32 v140, v129, v153, -v155 op_sel:[1,0,0] op_sel_hi:[1,0,0]
    v_fma_mix_f32 v141, v130, v154, -v155 op_sel:[1,0,0] op_sel_hi:[1,0,0]
    v_and_b32 v135, v158, v135
    v_cvt_pk_bf16_f32 v116, v138, v139
    v_fma_mix_f32 v138, v131, v152, -v155 op_sel:[1,0,0] op_sel_hi:[1,0,0]
    v_and_b32 v136, v156, v137
    v_fma_mix_f32 v139, v132, v153, -v155 op_sel:[1,0,0] op_sel_hi:[1,0,0]
    v_cvt_pk_bf16_f32 v117, v140, v141
    v_and_b32 v137, v157, v137
    v_cvt_pk_bf16_f32 v118, v138, v139
    v_fma_mix_f32 v138, v133, v142, -v148 op_sel:[0,0,0] op_sel_hi:[1,0,0]
    v_fma_mix_f32 v139, v134, v143, -v148 op_sel:[0,0,0] op_sel_hi:[1,0,0]
    v_add_u32 v130, v123, v123
    v_fma_mix_f32 v140, v135, v144, -v148 op_sel:[0,0,0] op_sel_hi:[1,0,0]
    v_fma_mix_f32 v141, v136, v142, -v148 op_sel:[0,0,0] op_sel_hi:[1,0,0]
    v_lshrrev_b32 v132, 8, v123
    v_cvt_pk_bf16_f32 v55, v138, v139
    v_fma_mix_f32 v138, v137, v143, -v148 op_sel:[0,0,0] op_sel_hi:[1,0,0]
    v_and_b32 v128, v156, v130
    v_fma_mix_f32 v139, v133, v145, -v148 op_sel:[1,0,0] op_sel_hi:[1,0,0]
    v_cvt_pk_bf16_f32 v56, v140, v141
    v_and_b32 v129, v157, v130
    v_fma_mix_f32 v140, v134, v146, -v148 op_sel:[1,0,0] op_sel_hi:[1,0,0]
    v_fma_mix_f32 v141, v135, v147, -v148 op_sel:[1,0,0] op_sel_hi:[1,0,0]
    v_and_b32 v130, v158, v130
    v_cvt_pk_bf16_f32 v57, v138, v139
    v_fma_mix_f32 v138, v136, v145, -v148 op_sel:[1,0,0] op_sel_hi:[1,0,0]
    v_and_b32 v131, v156, v132
    v_fma_mix_f32 v139, v137, v146, -v148 op_sel:[1,0,0] op_sel_hi:[1,0,0]
    v_cvt_pk_bf16_f32 v58, v140, v141
    v_and_b32 v132, v157, v132
    v_cvt_pk_bf16_f32 v59, v138, v139
    v_fma_mix_f32 v138, v128, v149, -v155 op_sel:[0,0,0] op_sel_hi:[1,0,0]
    v_fma_mix_f32 v139, v129, v150, -v155 op_sel:[0,0,0] op_sel_hi:[1,0,0]
    v_fma_mix_f32 v140, v130, v151, -v155 op_sel:[0,0,0] op_sel_hi:[1,0,0]
    v_fma_mix_f32 v141, v131, v149, -v155 op_sel:[0,0,0] op_sel_hi:[1,0,0]
    v_cvt_pk_bf16_f32 v119, v138, v139
    v_fma_mix_f32 v138, v132, v150, -v155 op_sel:[0,0,0] op_sel_hi:[1,0,0]
    v_fma_mix_f32 v139, v128, v152, -v155 op_sel:[1,0,0] op_sel_hi:[1,0,0]
    v_cvt_pk_bf16_f32 v120, v140, v141
    v_fma_mix_f32 v140, v129, v153, -v155 op_sel:[1,0,0] op_sel_hi:[1,0,0]
    v_fma_mix_f32 v141, v130, v154, -v155 op_sel:[1,0,0] op_sel_hi:[1,0,0]
    v_cvt_pk_bf16_f32 v121, v138, v139
    v_fma_mix_f32 v138, v131, v152, -v155 op_sel:[1,0,0] op_sel_hi:[1,0,0]
    v_fma_mix_f32 v139, v132, v153, -v155 op_sel:[1,0,0] op_sel_hi:[1,0,0]
    v_cvt_pk_bf16_f32 v122, v140, v141
    v_cvt_pk_bf16_f32 v123, v138, v139
    v_and_b32 v124, s35, v124
    v_lshrrev_b32 v124, v161, v124
    v_lshl_or_b32 v124, v126, v162, v124
    v_and_b32 v125, s35, v125
    v_lshrrev_b32 v125, v161, v125
    v_lshl_or_b32 v125, v127, v162, v125
    v_lshlrev_b32 v159, 16, v163
    v_lshlrev_b32 v160, 16, v164
    v_mul_f32 v144, s34, v159
    v_mul_f32 v148, v160, v159
    v_mul_f32 v147, 2.0, v144
    v_mul_f32 v143, 4.0, v147
    v_mul_f32 v146, 2.0, v143
    v_mul_f32 v142, 4.0, v146
    v_mul_f32 v145, 2.0, v142
    v_add_u32 v135, v124, v124
    v_lshrrev_b32 v137, 8, v124
    v_and_b32 v133, v156, v135
    v_and_b32 v134, v157, v135
    v_and_b32 v135, v158, v135
    v_and_b32 v136, v156, v137
    v_and_b32 v137, v157, v137
    v_fma_mix_f32 v138, v133, v142, -v148 op_sel:[0,0,0] op_sel_hi:[1,0,0]
    v_fma_mix_f32 v139, v134, v143, -v148 op_sel:[0,0,0] op_sel_hi:[1,0,0]
    v_add_u32 v130, v125, v125
    v_fma_mix_f32 v140, v135, v144, -v148 op_sel:[0,0,0] op_sel_hi:[1,0,0]
    v_fma_mix_f32 v141, v136, v142, -v148 op_sel:[0,0,0] op_sel_hi:[1,0,0]
    v_lshrrev_b32 v132, 8, v125
    v_cvt_pk_bf16_f32 v60, v138, v139
    v_fma_mix_f32 v138, v137, v143, -v148 op_sel:[0,0,0] op_sel_hi:[1,0,0]
    v_and_b32 v128, v156, v130
    v_fma_mix_f32 v139, v133, v145, -v148 op_sel:[1,0,0] op_sel_hi:[1,0,0]
    v_cvt_pk_bf16_f32 v61, v140, v141
    v_and_b32 v129, v157, v130
    v_fma_mix_f32 v140, v134, v146, -v148 op_sel:[1,0,0] op_sel_hi:[1,0,0]
    v_fma_mix_f32 v141, v135, v147, -v148 op_sel:[1,0,0] op_sel_hi:[1,0,0]
    v_and_b32 v130, v158, v130
    v_cvt_pk_bf16_f32 v62, v138, v139
    v_cvt_pk_bf16_f32 v63, v140, v141
    v_and_b32 v131, v156, v132
    v_and_b32 v132, v157, v132
    v_and_b32 v159, s52, v163
    v_and_b32 v160, s52, v164
    v_mul_f32 v151, s34, v159
    v_mul_f32 v155, v160, v159
    v_mul_f32 v154, 2.0, v151
    v_mul_f32 v150, 4.0, v154
    v_mul_f32 v153, 2.0, v150
    v_mul_f32 v149, 4.0, v153
    v_mul_f32 v152, 2.0, v149
    v_fma_mix_f32 v138, v128, v149, -v155 op_sel:[0,0,0] op_sel_hi:[1,0,0]
    v_fma_mix_f32 v139, v129, v150, -v155 op_sel:[0,0,0] op_sel_hi:[1,0,0]
    v_fma_mix_f32 v140, v130, v151, -v155 op_sel:[0,0,0] op_sel_hi:[1,0,0]
    v_fma_mix_f32 v141, v131, v149, -v155 op_sel:[0,0,0] op_sel_hi:[1,0,0]
    v_cvt_pk_bf16_f32 v124, v138, v139
    v_fma_mix_f32 v138, v132, v150, -v155 op_sel:[0,0,0] op_sel_hi:[1,0,0]
    v_fma_mix_f32 v139, v128, v152, -v155 op_sel:[1,0,0] op_sel_hi:[1,0,0]
    v_cvt_pk_bf16_f32 v125, v140, v141
    v_fma_mix_f32 v140, v129, v153, -v155 op_sel:[1,0,0] op_sel_hi:[1,0,0]
    v_fma_mix_f32 v141, v130, v154, -v155 op_sel:[1,0,0] op_sel_hi:[1,0,0]
    v_cvt_pk_bf16_f32 v126, v138, v139
    v_cvt_pk_bf16_f32 v127, v140, v141
    s_mov_b64 exec, s[32:33]
    v_mov_b32 v62, v60
    v_mov_b32 v63, v61
    v_mov_b32 v60, 0
    v_mov_b32 v61, 0
    v_mov_b32 v126, v124
    v_mov_b32 v127, v125
    v_mov_b32 v124, 0
    v_mov_b32 v125, 0
    s_mov_b64 exec, -1
    s_nop 1
    s_branch L_yf
.p2align 12
L_blk2:
L_yf:
L_pad4:
    s_cbranch_execz L_ret
    v_mov_b32 v169, v168
    v_mov_b32 v170, v172
    v_add_u32 v168, 33280, v168
    s_mov_b32 s66, 33280
    s_mov_b32 s67, 0
    s_add_u32 s68, s41, 13
    s_add_u32 s64, s44, 1605632
    s_setprio 2
    s_barrier
    ds_read_b128 v[128:131], v172 offset:0
    ds_read_b128 v[132:135], v172 offset:1024
    ds_read_b128 a[0:3], v168 offset:0
    ds_read_b128 a[4:7], v168 offset:16
    ds_read_b128 a[8:11], v168 offset:32
    ds_read_b128 a[12:15], v168 offset:48
    ds_read_b128 a[16:19], v168 offset:64
    ds_read_b128 a[20:23], v168 offset:80
    ds_read_b128 a[24:27], v168 offset:96
    ds_read_b128 a[28:31], v168 offset:112
.p2align 3
L_yloop:
    s_waitcnt lgkmcnt(6)
    v_mfma_f32_16x16x32_bf16 v[128:131], a[0:3], v[0:3], v[128:131]
    ds_read_b128 a[32:35], v168 offset:128
    v_mfma_f32_16x16x32_bf16 v[128:131], a[4:7], v[4:7], v[128:131]
    s_waitcnt lgkmcnt(5)
    v_mfma_f32_16x16x32_bf16 v[128:131], a[8:11], v[8:11], v[128:131]
    ds_read_b128 a[36:39], v168 offset:144
    v_cvt_pk_bf16_f32 v164, v136, v140
    v_mfma_f32_16x16x32_bf16 v[128:131], a[12:15], v[12:15], v[128:131]
    v_cvt_pk_bf16_f32 v165, v137, v141
    s_waitcnt lgkmcnt(4)
    v_mfma_f32_16x16x32_bf16 v[128:131], a[16:19], v[16:19], v[128:131]
    ds_read_b128 a[40:43], v168 offset:160
    v_cvt_pk_bf16_f32 v158, v138, v142
    v_mfma_f32_16x16x32_bf16 v[128:131], a[20:23], v[20:23], v[128:131]
    v_cvt_pk_bf16_f32 v159, v139, v143
    s_waitcnt lgkmcnt(3)
    v_mfma_f32_16x16x32_bf16 v[128:131], a[24:27], v[24:27], v[128:131]
    ds_read_b128 a[44:47], v168 offset:176
    v_cvt_pk_bf16_f32 v156, v136, v140
    v_mfma_f32_16x16x32_bf16 v[128:131], a[28:31], v[28:31], v[128:131]
    v_cvt_pk_bf16_f32 v157, v137, v141
    v_mfma_f32_16x16x32_bf16 v[132:135], a[0:3], v[64:67], v[132:135]
    ds_read_b128 a[48:51], v168 offset:192
    v_mov_b32_dpp v156, v158 row_ror:8 row_mask:0xf bank_mask:0xc
    v_mfma_f32_16x16x32_bf16 v[132:135], a[4:7], v[68:71], v[132:135]
    v_mov_b32_dpp v157, v159 row_ror:8 row_mask:0xf bank_mask:0xc
    v_mfma_f32_16x16x32_bf16 v[132:135], a[8:11], v[72:75], v[132:135]
    ds_read_b128 a[52:55], v168 offset:208
    v_mov_b32_dpp v158, v164 row_ror:8 row_mask:0xf bank_mask:0x3
    v_mfma_f32_16x16x32_bf16 v[132:135], a[12:15], v[76:79], v[132:135]
    v_mov_b32_dpp v159, v165 row_ror:8 row_mask:0xf bank_mask:0x3
    v_mov_b32 v164, v156
    v_mfma_f32_16x16x32_bf16 v[132:135], a[16:19], v[80:83], v[132:135]
    ds_read_b128 a[56:59], v168 offset:224
    v_mov_b32 v165, v158
    v_mfma_f32_16x16x32_bf16 v[132:135], a[20:23], v[84:87], v[132:135]
    v_mov_b32_dpp v156, v157 row_shr:4 row_mask:0xf bank_mask:0xa
    v_mfma_f32_16x16x32_bf16 v[132:135], a[24:27], v[88:91], v[132:135]
    ds_read_b128 a[60:63], v168 offset:240
    v_mov_b32_dpp v158, v159 row_shr:4 row_mask:0xf bank_mask:0xa
    v_mfma_f32_16x16x32_bf16 v[132:135], a[28:31], v[92:95], v[132:135]
    v_mov_b32_dpp v157, v164 row_shl:4 row_mask:0xf bank_mask:0x5
    s_waitcnt lgkmcnt(4)
    v_mfma_f32_16x16x32_bf16 v[128:131], a[32:35], v[32:35], v[128:131]
    ds_read_b128 a[0:3], v168 offset:16640
    v_mov_b32_dpp v159, v165 row_shl:4 row_mask:0xf bank_mask:0x5
    v_mfma_f32_16x16x32_bf16 v[128:131], a[36:39], v[36:39], v[128:131]
    ds_read_b128 v[136:139], v172 offset:2048
    v_mfma_f32_16x16x32_bf16 v[128:131], a[40:43], v[40:43], v[128:131]
    ds_read_b128 a[4:7], v168 offset:16656
L_pad5:
    s_cbranch_execz L_ret
    v_mfma_f32_16x16x32_bf16 v[128:131], a[44:47], v[44:47], v[128:131]
    ds_read_b128 v[140:143], v172 offset:3072
    s_waitcnt lgkmcnt(4)
    v_mfma_f32_16x16x32_bf16 v[128:131], a[48:51], v[48:51], v[128:131]
    ds_read_b128 a[8:11], v168 offset:16672
    s_add_u32 s67, s67, 16640
    v_mfma_f32_16x16x32_bf16 v[128:131], a[52:55], v[52:55], v[128:131]
    buffer_store_dwordx4 v[152:155], v173, s[24:27], s62 offen sc1
    v_mfma_f32_16x16x32_bf16 v[128:131], a[56:59], v[56:59], v[128:131]
    ds_read_b128 a[12:15], v168 offset:16688
    v_mfma_f32_16x16x32_bf16 v[128:131], a[60:63], v[60:63], v[128:131]
    buffer_store_dwordx4 v[156:159], v174, s[24:27], s62 offen sc1
    v_mfma_f32_16x16x32_bf16 v[132:135], a[32:35], v[96:99], v[132:135]
    ds_read_b128 a[16:19], v168 offset:16704
    v_mfma_f32_16x16x32_bf16 v[132:135], a[36:39], v[100:103], v[132:135]
    s_cmp_eq_u32 s67, 49920
    s_cselect_b32 s67, 0, s67
    v_mfma_f32_16x16x32_bf16 v[132:135], a[40:43], v[104:107], v[132:135]
    ds_read_b128 a[20:23], v168 offset:16720
    v_add_u32 v172, s67, v170
    v_mfma_f32_16x16x32_bf16 v[132:135], a[44:47], v[108:111], v[132:135]
    s_add_u32 s66, s66, 33280
    v_mfma_f32_16x16x32_bf16 v[132:135], a[48:51], v[112:115], v[132:135]
    ds_read_b128 a[24:27], v168 offset:16736
    v_mfma_f32_16x16x32_bf16 v[132:135], a[52:55], v[116:119], v[132:135]
    s_cmp_eq_u32 s66, 99840
    s_cselect_b32 s66, 0, s66
    v_mfma_f32_16x16x32_bf16 v[132:135], a[56:59], v[120:123], v[132:135]
    s_sub_u32 s68, s68, 1
    ds_read_b128 a[28:31], v168 offset:16752
    v_mfma_f32_16x16x32_bf16 v[132:135], a[60:63], v[124:127], v[132:135]
    s_cbranch_scc1 L_yt0
    s_waitcnt lgkmcnt(4)
    v_mfma_f32_16x16x32_bf16 v[136:139], a[0:3], v[0:3], v[136:139]
    ds_read_b128 a[32:35], v168 offset:16768
    v_mfma_f32_16x16x32_bf16 v[136:139], a[4:7], v[4:7], v[136:139]
    ds_read_b128 a[36:39], v168 offset:16784
    v_mfma_f32_16x16x32_bf16 v[136:139], a[8:11], v[8:11], v[136:139]
    ds_read_b128 a[40:43], v168 offset:16800
    v_cvt_pk_bf16_f32 v164, v128, v132
    v_mfma_f32_16x16x32_bf16 v[136:139], a[12:15], v[12:15], v[136:139]
    ds_read_b128 a[44:47], v168 offset:16816
    s_waitcnt lgkmcnt(4)
    v_mfma_f32_16x16x32_bf16 v[136:139], a[16:19], v[16:19], v[136:139]
    ds_read_b128 a[48:51], v168 offset:16832
    v_cvt_pk_bf16_f32 v165, v129, v133
    v_mfma_f32_16x16x32_bf16 v[136:139], a[20:23], v[20:23], v[136:139]
    ds_read_b128 a[52:55], v168 offset:16848
    v_cvt_pk_bf16_f32 v154, v130, v134
    v_mfma_f32_16x16x32_bf16 v[136:139], a[24:27], v[24:27], v[136:139]
    ds_read_b128 a[56:59], v168 offset:16864
    v_cvt_pk_bf16_f32 v155, v131, v135
    v_mfma_f32_16x16x32_bf16 v[136:139], a[28:31], v[28:31], v[136:139]
    ds_read_b128 a[60:63], v168 offset:16880
    v_cvt_pk_bf16_f32 v152, v128, v132
    v_mfma_f32_16x16x32_bf16 v[140:143], a[0:3], v[64:67], v[140:143]
    v_cvt_pk_bf16_f32 v153, v129, v133
    v_add_u32 v168, s66, v169
    v_mfma_f32_16x16x32_bf16 v[140:143], a[4:7], v[68:71], v[140:143]
    v_mov_b32_dpp v152, v154 row_ror:8 row_mask:0xf bank_mask:0xc
    v_mfma_f32_16x16x32_bf16 v[140:143], a[8:11], v[72:75], v[140:143]
    s_waitcnt lgkmcnt(0)
    s_barrier
    v_mfma_f32_16x16x32_bf16 v[140:143], a[12:15], v[76:79], v[140:143]
    v_mov_b32_dpp v153, v155 row_ror:8 row_mask:0xf bank_mask:0xc
    v_mfma_f32_16x16x32_bf16 v[140:143], a[16:19], v[80:83], v[140:143]
    v_mov_b32_dpp v154, v164 row_ror:8 row_mask:0xf bank_mask:0x3
    v_mfma_f32_16x16x32_bf16 v[140:143], a[20:23], v[84:87], v[140:143]
    v_mov_b32_dpp v155, v165 row_ror:8 row_mask:0xf bank_mask:0x3
L_pad6:
    s_cbranch_execz L_ret
    v_mov_b32 v164, v152
    v_mfma_f32_16x16x32_bf16 v[140:143], a[24:27], v[88:91], v[140:143]
    v_mov_b32 v165, v154
    v_mov_b32_dpp v152, v153 row_shr:4 row_mask:0xf bank_mask:0xa
    v_mfma_f32_16x16x32_bf16 v[140:143], a[28:31], v[92:95], v[140:143]
    v_mov_b32_dpp v154, v155 row_shr:4 row_mask:0xf bank_mask:0xa
    v_mfma_f32_16x16x32_bf16 v[136:139], a[32:35], v[32:35], v[136:139]
    s_mov_b32 s62, s63
    v_mov_b32_dpp v153, v164 row_shl:4 row_mask:0xf bank_mask:0x5
    v_mfma_f32_16x16x32_bf16 v[136:139], a[36:39], v[36:39], v[136:139]
    v_mov_b32_dpp v155, v165 row_shl:4 row_mask:0xf bank_mask:0x5
    s_add_u32 s63, s63, 229376
    v_mfma_f32_16x16x32_bf16 v[136:139], a[40:43], v[40:43], v[136:139]
    s_cmp_eq_u32 s63, s64
    s_cselect_b32 s63, s44, s63
    v_mfma_f32_16x16x32_bf16 v[136:139], a[44:47], v[44:47], v[136:139]
    v_mfma_f32_16x16x32_bf16 v[136:139], a[48:51], v[48:51], v[136:139]
    ds_read_b128 v[128:131], v172 offset:0
    v_mfma_f32_16x16x32_bf16 v[136:139], a[52:55], v[52:55], v[136:139]
    ds_read_b128 v[132:135], v172 offset:1024
    v_mfma_f32_16x16x32_bf16 v[136:139], a[56:59], v[56:59], v[136:139]
    ds_read_b128 a[0:3], v168 offset:0
    v_mfma_f32_16x16x32_bf16 v[136:139], a[60:63], v[60:63], v[136:139]
    ds_read_b128 a[4:7], v168 offset:16
    v_mfma_f32_16x16x32_bf16 v[140:143], a[32:35], v[96:99], v[140:143]
    ds_read_b128 a[8:11], v168 offset:32
    v_mfma_f32_16x16x32_bf16 v[140:143], a[36:39], v[100:103], v[140:143]
    ds_read_b128 a[12:15], v168 offset:48
    v_mfma_f32_16x16x32_bf16 v[140:143], a[40:43], v[104:107], v[140:143]
    ds_read_b128 a[16:19], v168 offset:64
    v_mfma_f32_16x16x32_bf16 v[140:143], a[44:47], v[108:111], v[140:143]
    ds_read_b128 a[20:23], v168 offset:80
    v_mfma_f32_16x16x32_bf16 v[140:143], a[48:51], v[112:115], v[140:143]
    ds_read_b128 a[24:27], v168 offset:96
    v_mfma_f32_16x16x32_bf16 v[140:143], a[52:55], v[116:119], v[140:143]
    ds_read_b128 a[28:31], v168 offset:112
    v_mfma_f32_16x16x32_bf16 v[140:143], a[56:59], v[120:123], v[140:143]
    s_sub_u32 s68, s68, 1
    v_mfma_f32_16x16x32_bf16 v[140:143], a[60:63], v[124:127], v[140:143]
    s_cbranch_scc0 L_yloop
    buffer_store_dwordx4 v[152:155], v173, s[24:27], s62 offen sc1
    s_nop 5
    v_cvt_pk_bf16_f32 v164, v136, v140
    v_cvt_pk_bf16_f32 v165, v137, v141
    v_cvt_pk_bf16_f32 v158, v138, v142
    v_cvt_pk_bf16_f32 v159, v139, v143
    v_cvt_pk_bf16_f32 v156, v136, v140
    v_cvt_pk_bf16_f32 v157, v137, v141
    s_nop 0
    v_mov_b32_dpp v156, v158 row_ror:8 row_mask:0xf bank_mask:0xc
    v_mov_b32_dpp v157, v159 row_ror:8 row_mask:0xf bank_mask:0xc
    v_mov_b32_dpp v158, v164 row_ror:8 row_mask:0xf bank_mask:0x3
    v_mov_b32_dpp v159, v165 row_ror:8 row_mask:0xf bank_mask:0x3
    v_mov_b32 v164, v156
    v_mov_b32 v165, v158
    v_mov_b32_dpp v156, v157 row_shr:4 row_mask:0xf bank_mask:0xa
    v_mov_b32_dpp v158, v159 row_shr:4 row_mask:0xf bank_mask:0xa
    v_mov_b32_dpp v157, v164 row_shl:4 row_mask:0xf bank_mask:0x5
    v_mov_b32_dpp v159, v165 row_shl:4 row_mask:0xf bank_mask:0x5
    buffer_store_dwordx4 v[156:159], v174, s[24:27], s62 offen sc1
    s_branch L_yend
L_yt0:
    s_nop 6
    v_cvt_pk_bf16_f32 v164, v128, v132
    v_cvt_pk_bf16_f32 v165, v129, v133
    v_cvt_pk_bf16_f32 v154, v130, v134
    v_cvt_pk_bf16_f32 v155, v131, v135
    v_cvt_pk_bf16_f32 v152, v128, v132
    v_cvt_pk_bf16_f32 v153, v129, v133
    s_nop 0
    v_mov_b32_dpp v152, v154 row_ror:8 row_mask:0xf bank_mask:0xc
L_hp0:
    s_cbranch_execz L_hret
    v_mov_b32_dpp v153, v155 row_ror:8 row_mask:0xf bank_mask:0xc
    v_mov_b32_dpp v154, v164 row_ror:8 row_mask:0xf bank_mask:0x3
    v_mov_b32_dpp v155, v165 row_ror:8 row_mask:0xf bank_mask:0x3
    v_mov_b32 v164, v152
    v_mov_b32 v165, v154
    v_mov_b32_dpp v152, v153 row_shr:4 row_mask:0xf bank_mask:0xa
    v_mov_b32_dpp v154, v155 row_shr:4 row_mask:0xf bank_mask:0xa
    v_mov_b32_dpp v153, v164 row_shl:4 row_mask:0xf bank_mask:0x5
    v_mov_b32_dpp v155, v165 row_shl:4 row_mask:0xf bank_mask:0x5
    buffer_store_dwordx4 v[152:155], v173, s[24:27], s65 offen sc1
L_yend:
    s_endpgm
L_s6join:
    s_setprio 0
    s_add_u32 s56, s39, 2
    s_sub_u32 s51, s56, 7
    s_min_u32 s56, s56, s51
    s_mul_i32 s56, s56, 65280
    s_add_u32 s56, s56, s43
    s_add_u32 m0, s42, 0
    s_add_u32 s51, s56, 0
    buffer_load_dwordx4 v171, s[8:11], s56 offen lds
    s_add_u32 m0, s42, 1040
    s_add_u32 s51, s56, 2040
    buffer_load_dwordx4 v171, s[8:11], s51 offen lds
    s_add_u32 m0, s42, 2080
    s_add_u32 s51, s56, 4080
    buffer_load_dwordx4 v171, s[8:11], s51 offen lds
    s_add_u32 m0, s42, 3120
    s_add_u32 s51, s56, 6120
    buffer_load_dwordx4 v171, s[8:11], s51 offen lds
    s_add_u32 m0, s42, 4160
    s_add_u32 s51, s56, 8160
    buffer_load_dwordx4 v171, s[8:11], s51 offen lds
    s_add_u32 m0, s42, 5200
    s_add_u32 s51, s56, 10200
    buffer_load_dwordx4 v171, s[8:11], s51 offen lds
    s_add_u32 m0, s42, 6240
    s_add_u32 s51, s56, 12240
    buffer_load_dwordx4 v171, s[8:11], s51 offen lds
    s_add_u32 m0, s42, 7280
    s_add_u32 s51, s56, 14280
    buffer_load_dwordx4 v171, s[8:11], s51 offen lds
    s_mov_b64 exec, 0
    s_cmp_eq_u32 s40, 0
    s_cbranch_scc1 L_hp0
    s_cmp_eq_u32 s40, 1
    s_cbranch_scc1 L_hp1
    s_cmp_eq_u32 s40, 2
    s_cbranch_scc1 L_hp2
    s_branch L_hret
L_hret:
    s_mov_b64 exec, -1
    s_waitcnt vmcnt(8)
    s_barrier
    ds_write_b128 v172, a[64:67] offset:33280
    ds_write_b128 v172, a[68:71] offset:34304
    ds_write_b128 v172, a[72:75] offset:35328
    ds_write_b128 v172, a[76:79] offset:36352
    s_add_u32 s57, s39, 3
    s_sub_u32 s51, s57, 7
    s_min_u32 s57, s57, s51
    s_mul_i32 s57, s57, 65280
    s_add_u32 s57, s57, s43
    s_add_u32 m0, s42, 33280
    s_add_u32 s51, s57, 0
    buffer_load_dwordx4 v171, s[8:11], s57 offen lds
    s_add_u32 m0, s42, 34320
    s_add_u32 s51, s57, 2040
    buffer_load_dwordx4 v171, s[8:11], s51 offen lds
    s_add_u32 m0, s42, 35360
    s_add_u32 s51, s57, 4080
    buffer_load_dwordx4 v171, s[8:11], s51 offen lds
    s_add_u32 m0, s42, 36400
    s_add_u32 s51, s57, 6120
    buffer_load_dwordx4 v171, s[8:11], s51 offen lds
    s_add_u32 m0, s42, 37440
    s_add_u32 s51, s57, 8160
    buffer_load_dwordx4 v171, s[8:11], s51 offen lds
    s_add_u32 m0, s42, 38480
L_hp1:
    s_cbranch_execz L_hret
    s_add_u32 s51, s57, 10200
    buffer_load_dwordx4 v171, s[8:11], s51 offen lds
    s_add_u32 m0, s42, 39520
    s_add_u32 s51, s57, 12240
    buffer_load_dwordx4 v171, s[8:11], s51 offen lds
    s_add_u32 m0, s42, 40560
    s_add_u32 s51, s57, 14280
    buffer_load_dwordx4 v171, s[8:11], s51 offen lds
    s_waitcnt vmcnt(8) lgkmcnt(0)
    s_barrier
    ds_write_b128 v172, v[128:131] offset:0
    ds_write_b128 v172, v[132:135] offset:1024
    ds_write_b128 v172, v[136:139] offset:2048
    ds_write_b128 v172, v[140:143] offset:3072
    s_add_u32 m0, s42, 66560
    s_add_u32 s51, s58, 0
    buffer_load_dwordx4 v171, s[8:11], s58 offen lds
    s_add_u32 m0, s42, 67600
    s_add_u32 s51, s58, 2040
    buffer_load_dwordx4 v171, s[8:11], s51 offen lds
    s_add_u32 m0, s42, 68640
    s_add_u32 s51, s58, 4080
    buffer_load_dwordx4 v171, s[8:11], s51 offen lds
    s_add_u32 m0, s42, 69680
    s_add_u32 s51, s58, 6120
    buffer_load_dwordx4 v171, s[8:11], s51 offen lds
    s_add_u32 m0, s42, 70720
    s_add_u32 s51, s58, 8160
    buffer_load_dwordx4 v171, s[8:11], s51 offen lds
    s_add_u32 m0, s42, 71760
    s_add_u32 s51, s58, 10200
    buffer_load_dwordx4 v171, s[8:11], s51 offen lds
    s_add_u32 m0, s42, 72800
    s_add_u32 s51, s58, 12240
    buffer_load_dwordx4 v171, s[8:11], s51 offen lds
    s_add_u32 m0, s42, 73840
    s_add_u32 s51, s58, 14280
    buffer_load_dwordx4 v171, s[8:11], s51 offen lds
    s_waitcnt vmcnt(8) lgkmcnt(0)
    s_barrier
    ds_write_b128 v172, v[144:147] offset:16640
    ds_write_b128 v172, v[148:151] offset:17664
    ds_write_b128 v172, v[152:155] offset:18688
    ds_write_b128 v172, v[156:159] offset:19712
    s_add_u32 m0, s42, 0
    s_add_u32 s51, s59, 0
    buffer_load_dwordx4 v171, s[8:11], s59 offen lds
    s_add_u32 m0, s42, 1040
    s_add_u32 s51, s59, 2040
    buffer_load_dwordx4 v171, s[8:11], s51 offen lds
    s_add_u32 m0, s42, 2080
    s_add_u32 s51, s59, 4080
    buffer_load_dwordx4 v171, s[8:11], s51 offen lds
    s_add_u32 m0, s42, 3120
    s_add_u32 s51, s59, 6120
    buffer_load_dwordx4 v171, s[8:11], s51 offen lds
    s_add_u32 m0, s42, 4160
    s_add_u32 s51, s59, 8160
    buffer_load_dwordx4 v171, s[8:11], s51 offen lds
    s_add_u32 m0, s42, 5200
    s_add_u32 s51, s59, 10200
    buffer_load_dwordx4 v171, s[8:11], s51 offen lds
    s_add_u32 m0, s42, 6240
    s_add_u32 s51, s59, 12240
    buffer_load_dwordx4 v171, s[8:11], s51 offen lds
    s_add_u32 m0, s42, 7280
    s_add_u32 s51, s59, 14280
L_hp2:
    s_cbranch_execz L_hret
    buffer_load_dwordx4 v171, s[8:11], s51 offen lds
    s_waitcnt vmcnt(8) lgkmcnt(0)
    s_barrier
    ds_write_b128 v172, a[32:35] offset:33280
    ds_write_b128 v172, a[36:39] offset:34304
    ds_write_b128 v172, a[40:43] offset:35328
    ds_write_b128 v172, a[44:47] offset:36352
    s_add_u32 m0, s42, 33280
    s_add_u32 s51, s60, 0
    buffer_load_dwordx4 v171, s[8:11], s60 offen lds
    s_add_u32 m0, s42, 34320
    s_add_u32 s51, s60, 2040
    buffer_load_dwordx4 v171, s[8:11], s51 offen lds
    s_add_u32 m0, s42, 35360
    s_add_u32 s51, s60, 4080
    buffer_load_dwordx4 v171, s[8:11], s51 offen lds
    s_add_u32 m0, s42, 36400
    s_add_u32 s51, s60, 6120
    buffer_load_dwordx4 v171, s[8:11], s51 offen lds
    s_add_u32 m0, s42, 37440
    s_add_u32 s51, s60, 8160
    buffer_load_dwordx4 v171, s[8:11], s51 offen lds
    s_add_u32 m0, s42, 38480
    s_add_u32 s51, s60, 10200
    buffer_load_dwordx4 v171, s[8:11], s51 offen lds
    s_add_u32 m0, s42, 39520
    s_add_u32 s51, s60, 12240
    buffer_load_dwordx4 v171, s[8:11], s51 offen lds
    s_add_u32 m0, s42, 40560
    s_add_u32 s51, s60, 14280
    buffer_load_dwordx4 v171, s[8:11], s51 offen lds
    s_waitcnt vmcnt(8) lgkmcnt(0)
    s_barrier
    ds_write_b128 v172, a[48:51] offset:0
    ds_write_b128 v172, a[52:55] offset:1024
    ds_write_b128 v172, a[56:59] offset:2048
    ds_write_b128 v172, a[60:63] offset:3072
    s_waitcnt vmcnt(0)
    s_cmp_eq_u32 s41, 0
    s_cbranch_scc1 L_nox
    s_mul_i32 s61, s40, 8160
    s_sub_u32 s61, s43, s61
    s_add_u32 s61, s61, 456960
    s_lshr_b32 s45, s42, 1
    s_add_u32 m0, s45, 66560
    s_add_u32 s51, s61, 0
    buffer_load_dwordx4 v171, s[8:11], s51 offen lds
    s_add_u32 m0, s45, 67600
    s_add_u32 s51, s61, 2040
    buffer_load_dwordx4 v171, s[8:11], s51 offen lds
    s_add_u32 m0, s45, 68640
    s_add_u32 s51, s61, 4080
    buffer_load_dwordx4 v171, s[8:11], s51 offen lds
    s_add_u32 m0, s45, 69680
    s_add_u32 s51, s61, 6120
    buffer_load_dwordx4 v171, s[8:11], s51 offen lds
L_nox:
    s_waitcnt lgkmcnt(0)
    s_barrier
    s_cmp_eq_u32 s41, 0
    s_cbranch_scc1 L_oend
    ds_write_b128 v172, v[160:163] offset:16640
    ds_write_b128 v172, v[164:167] offset:17664
    s_waitcnt vmcnt(0) lgkmcnt(0)
    s_barrier
L_oend:
    s_endpgm
L_fin:
L_end:
    s_endpgm
.set CODE_BYTES, L_end - standalone__weight_only_int_gptq__prompt_kernel - 128
.section .rodata,"a"
.p2align 6
.amdhsa_kernel standalone__weight_only_int_gptq__prompt_kernel
  .amdhsa_next_free_vgpr 256
  .amdhsa_next_free_sgpr 102
  .amdhsa_accum_offset 176
  .amdhsa_group_segment_fixed_size 0
  .amdhsa_kernarg_size 64
  .amdhsa_user_sgpr_count 2
  .amdhsa_user_sgpr_kernarg_segment_ptr 1
  .amdhsa_system_sgpr_workgroup_id_x 1
.end_amdhsa_kernel
```
